```python
import torch

def _softmax(x, axis=-1):
    return torch.softmax(x, dim=axis)

def _gelu(x):
    return torch.nn.functional.gelu(x, approximate='tanh')

def _silu(x):
    return torch.nn.functional.silu(x)

def _sigmoid(x):
    return torch.sigmoid(x)

def _layernorm(x, axis=-1, eps=1e-05):
    m = x.mean(dim=axis, keepdim=True)
    v = x.var(dim=axis, keepdim=True, unbiased=False)
    return (x - m) / torch.sqrt(v + eps)

def _scatter_add(tgt, idx, src, axis=0):
    return tgt.clone().index_add_(axis, idx, src)

def _segment_sum(src, seg, n):
    out = torch.zeros((n,) + src.shape[1:], dtype=src.dtype)
    return out.index_add_(0, seg, src)

def _pad(x, pw):
    flat = tuple((v for pair in reversed(pw) for v in pair))
    return torch.nn.functional.pad(x, flat)
kernel_name = 'parallel_sum__memory_aug_recurrent_mem_tr__dense_activation_gelu__prompt'

def setup_inputs():

    _w = lambda a: (lambda t: t.to(torch.bfloat16) if t.is_floating_point() else t)(torch.as_tensor(a))

    def _A_setup():
        B, S, Dm = (1, 2048, 1024)
        H, Dh = (32, 128)
        M, seg = (8, 32)
        seg = min(seg, S)
        S = S // seg * seg
        return {'x': _w((lambda *s: torch.randn(*s, dtype=torch.bfloat16) * 0.05)(B, S, Dm)), 'mem0': _w((lambda *s: torch.randn(*s, dtype=torch.bfloat16) * 0.2)(B, M, Dm)), 'Wq': _w((lambda *s: torch.randn(*s, dtype=torch.bfloat16) * 1.6)(Dm, H, Dh) * Dm ** (-0.5)), 'Wk': _w((lambda *s: torch.randn(*s, dtype=torch.bfloat16) * 1.6)(Dm, H, Dh) * Dm ** (-0.5)), 'Wv': _w((lambda *s: torch.randn(*s, dtype=torch.bfloat16) * 0.2)(Dm, H, Dh) * Dm ** (-0.5)), 'Wo': _w((lambda *s: torch.randn(*s, dtype=torch.bfloat16) * 0.2)(H, Dh, Dm) * (H * Dh) ** (-0.5)), 'seg_len': seg}
    _A_in = _A_setup()

    def _B_setup():
        B, S, D, F = (1, 2048, 1024, 3584)
        return {'x': _w((lambda *s: torch.randn(*s, dtype=torch.bfloat16) * 0.05)(B, S, D)), 'w1': _w((lambda *s: torch.randn(*s, dtype=torch.bfloat16) * 0.4)(D, F) * D ** (-0.5)), 'b1': _w((lambda *s: torch.randn(*s, dtype=torch.bfloat16) * 12.8)(F) * 0.01), 'w2': _w((lambda *s: torch.randn(*s, dtype=torch.bfloat16) * 0.1)(F, D) * F ** (-0.5)), 'b2': _w((lambda *s: torch.randn(*s, dtype=torch.bfloat16) * 1.6)(D) * 0.01)}
    _B_in = _B_setup()
    return {'A_x': _A_in['x'], 'A_mem0': _A_in['mem0'], 'A_Wq': _A_in['Wq'], 'A_Wk': _A_in['Wk'], 'A_Wv': _A_in['Wv'], 'A_Wo': _A_in['Wo'], 'A_seg_len': _A_in['seg_len'], 'B_x': _B_in['x'], 'B_w1': _B_in['w1'], 'B_b1': _B_in['b1'], 'B_w2': _B_in['w2'], 'B_b2': _B_in['b2']}

def reference(A_x, A_mem0, A_Wq, A_Wk, A_Wv, A_Wo, A_seg_len, B_x, B_w1, B_b1, B_w2, B_b2):

    def _A_ref(x, mem0, Wq, Wk, Wv, Wo, seg_len):
        B, S, Dm = x.shape
        H, Dh = (Wq.shape[1], Wq.shape[2])
        M = mem0.shape[1]
        scale = Dh ** (-0.5)
        n_seg = S // seg_len
        L = M + seg_len
        idx = torch.arange(L)
        mask = (idx[:, None] < M) | (idx[:, None] >= idx[None, :])
        mem = mem0
        outs = []
        for s in range(n_seg):
            xs = x[:, s * seg_len:(s + 1) * seg_len, :].clone()
            h = torch.concatenate([mem, xs], axis=1)
            q = torch.einsum('btd,dhe->bhte', h, Wq)
            k = torch.einsum('btd,dhe->bhte', h, Wk)
            v = torch.einsum('btd,dhe->bhte', h, Wv)
            scores = torch.einsum('bhqe,bhke->bhqk', q, k) * scale
            scores = torch.where(mask[None, None], scores, -1000000000.0)
            p = _softmax(scores, axis=-1)
            o = torch.einsum('bhqk,bhke->bhqe', p, v)
            o = torch.einsum('bhte,hed->btd', o, Wo)
            mem = o[:, :M, :].clone()
            outs.append(o[:, M:, :])
        return torch.concatenate(outs, axis=1)

    def _B_ref(x, w1, b1, w2, b2):
        h = torch.einsum('bsd,df->bsf', x, w1) + b1
        h = _gelu(h)
        return torch.einsum('bsf,fd->bsd', h, w2) + b2
    x = A_x
    xn = _layernorm(x, axis=-1)
    return x + _A_ref(xn, A_mem0, A_Wq, A_Wk, A_Wv, A_Wo, A_seg_len) + _B_ref(xn, B_w1, B_b1, B_w2, B_b2)
```

```asm
; @launch kernel=ln_kernel grid=(512,1,1) block=(256,1,1) lds=0
; @launch kernel=gemm1_kernel grid=(1984,1,1) block=(256,1,1) lds=77824
; @launch kernel=rec_kernel grid=(256,1,1) block=(512,1,1) lds=64768
; @launch kernel=att_kernel grid=(512,1,1) block=(256,1,1) lds=73728
; @launch kernel=gemm2_kernel grid=(256,1,1) block=(256,1,1) lds=77824
; @launch kernel=fin_kernel grid=(1024,1,1) block=(256,1,1) lds=0
.amdgcn_target "amdgcn-amd-amdhsa--gfx950"
.text
.globl ln_kernel
.p2align 8
.type ln_kernel,@function
ln_kernel:
    s_cmp_ge_u32 s2, 512
    s_cbranch_scc1 LN_done
    s_load_dwordx2 s[4:5], s[0:1], 0
    s_load_dwordx2 s[6:7], s[0:1], 112
    v_lshrrev_b32 v1, 6, v0
    v_and_b32 v2, 63, v0
    s_lshl_b32 s3, s2, 2
    v_add_u32 v3, s3, v1
    v_lshlrev_b32 v3, 11, v3
    v_lshlrev_b32 v4, 4, v2
    v_add_u32 v3, v3, v4
    v_xor_b32 v40, 1, v2
    v_lshlrev_b32 v40, 2, v40
    v_xor_b32 v41, 2, v2
    v_lshlrev_b32 v41, 2, v41
    v_xor_b32 v42, 4, v2
    v_lshlrev_b32 v42, 2, v42
    v_xor_b32 v43, 8, v2
    v_lshlrev_b32 v43, 2, v43
    v_xor_b32 v44, 16, v2
    v_lshlrev_b32 v44, 2, v44
    v_xor_b32 v45, 32, v2
    v_lshlrev_b32 v45, 2, v45
    s_waitcnt lgkmcnt(0)
    s_mov_b32 s8, s4
    s_and_b32 s9, s5, 0xffff
    s_mov_b32 s10, 4194304
    s_mov_b32 s11, 0x00020000
    s_mov_b32 s12, s6
    s_and_b32 s13, s7, 0xffff
    s_mov_b32 s14, 4194304
    s_mov_b32 s15, 0x00020000
    buffer_load_dwordx4 v[4:7], v3, s[8:11], 0 offen
    buffer_load_dwordx4 v[8:11], v3, s[8:11], 0 offen offset:1024
    s_add_u32 s16, s6, 96468992
    s_addc_u32 s17, s7, 0
    s_mov_b32 s28, s16
    s_and_b32 s29, s17, 0xffff
    s_mov_b32 s30, 8388608
    s_mov_b32 s31, 0x00020000
    s_lshl_b32 s18, s2, 14
    v_lshlrev_b32 v46, 6, v0
    v_mov_b32 v12, 0
    v_mov_b32 v13, 0
    v_mov_b32 v14, 0
    v_mov_b32 v15, 0
    buffer_store_dwordx4 v[12:15], v46, s[28:31], s18 offen
    buffer_store_dwordx4 v[12:15], v46, s[28:31], s18 offen offset:16
    buffer_store_dwordx4 v[12:15], v46, s[28:31], s18 offen offset:32
    buffer_store_dwordx4 v[12:15], v46, s[28:31], s18 offen offset:48
    s_cmp_lg_u32 s2, 0
    s_cbranch_scc1 LN_noflag
    v_cmp_gt_u32 vcc, 64, v0
    s_and_saveexec_b64 s[20:21], vcc
    s_cbranch_execz LN_flagdone
    s_add_u32 s16, s6, 109051904
    s_addc_u32 s17, s7, 0
    s_mov_b32 s24, s16
    s_and_b32 s25, s17, 0xffff
    s_mov_b32 s26, 131072
    s_mov_b32 s27, 0x00020000
    v_lshlrev_b32 v46, 7, v2
    v_mov_b32 v47, 0
    buffer_store_dword v47, v46, s[24:27], 0 offen
    v_add_u32 v46, 0x2000, v46
    buffer_store_dword v47, v46, s[24:27], 0 offen
    v_add_u32 v46, 0x2000, v46
    buffer_store_dword v47, v46, s[24:27], 0 offen
    v_add_u32 v46, 0x2000, v46
    buffer_store_dword v47, v46, s[24:27], 0 offen
    v_add_u32 v46, 0x2000, v46
    buffer_store_dword v47, v46, s[24:27], 0 offen
    v_add_u32 v46, 0x2000, v46
    buffer_store_dword v47, v46, s[24:27], 0 offen
    v_add_u32 v46, 0x2000, v46
    buffer_store_dword v47, v46, s[24:27], 0 offen
    v_add_u32 v46, 0x2000, v46
    buffer_store_dword v47, v46, s[24:27], 0 offen
    v_add_u32 v46, 0x2000, v46
LN_flagdone:
    s_mov_b64 exec, s[20:21]
LN_noflag:
    s_waitcnt vmcnt(0)
    v_lshlrev_b32 v16, 16, v4
    v_and_b32 v17, 0xffff0000, v4
    v_lshlrev_b32 v18, 16, v5
    v_and_b32 v19, 0xffff0000, v5
    v_lshlrev_b32 v20, 16, v6
    v_and_b32 v21, 0xffff0000, v6
    v_lshlrev_b32 v22, 16, v7
    v_and_b32 v23, 0xffff0000, v7
    v_lshlrev_b32 v24, 16, v8
    v_and_b32 v25, 0xffff0000, v8
    v_lshlrev_b32 v26, 16, v9
    v_and_b32 v27, 0xffff0000, v9
    v_lshlrev_b32 v28, 16, v10
    v_and_b32 v29, 0xffff0000, v10
    v_lshlrev_b32 v30, 16, v11
    v_and_b32 v31, 0xffff0000, v11
    v_add_f32 v32, v16, v17
    v_add_f32 v32, v32, v18
    v_add_f32 v32, v32, v19
    v_add_f32 v32, v32, v20
    v_add_f32 v32, v32, v21
    v_add_f32 v32, v32, v22
    v_add_f32 v32, v32, v23
    v_add_f32 v32, v32, v24
    v_add_f32 v32, v32, v25
    v_add_f32 v32, v32, v26
    v_add_f32 v32, v32, v27
    v_add_f32 v32, v32, v28
    v_add_f32 v32, v32, v29
    v_add_f32 v32, v32, v30
    v_add_f32 v32, v32, v31
    ds_bpermute_b32 v33, v40, v32
    s_waitcnt lgkmcnt(0)
    v_add_f32 v32, v32, v33
    ds_bpermute_b32 v33, v41, v32
    s_waitcnt lgkmcnt(0)
    v_add_f32 v32, v32, v33
    ds_bpermute_b32 v33, v42, v32
    s_waitcnt lgkmcnt(0)
    v_add_f32 v32, v32, v33
    ds_bpermute_b32 v33, v43, v32
    s_waitcnt lgkmcnt(0)
    v_add_f32 v32, v32, v33
    ds_bpermute_b32 v33, v44, v32
    s_waitcnt lgkmcnt(0)
    v_add_f32 v32, v32, v33
    ds_bpermute_b32 v33, v45, v32
    s_waitcnt lgkmcnt(0)
    v_add_f32 v32, v32, v33
    v_mul_f32 v32, 0x3a800000, v32
    v_mov_b32 v34, 0
    v_sub_f32 v35, v16, v32
    v_fmac_f32 v34, v35, v35
    v_sub_f32 v35, v17, v32
    v_fmac_f32 v34, v35, v35
    v_sub_f32 v35, v18, v32
    v_fmac_f32 v34, v35, v35
    v_sub_f32 v35, v19, v32
    v_fmac_f32 v34, v35, v35
    v_sub_f32 v35, v20, v32
    v_fmac_f32 v34, v35, v35
    v_sub_f32 v35, v21, v32
    v_fmac_f32 v34, v35, v35
    v_sub_f32 v35, v22, v32
    v_fmac_f32 v34, v35, v35
    v_sub_f32 v35, v23, v32
    v_fmac_f32 v34, v35, v35
    v_sub_f32 v35, v24, v32
    v_fmac_f32 v34, v35, v35
    v_sub_f32 v35, v25, v32
    v_fmac_f32 v34, v35, v35
    v_sub_f32 v35, v26, v32
    v_fmac_f32 v34, v35, v35
    v_sub_f32 v35, v27, v32
    v_fmac_f32 v34, v35, v35
    v_sub_f32 v35, v28, v32
    v_fmac_f32 v34, v35, v35
    v_sub_f32 v35, v29, v32
    v_fmac_f32 v34, v35, v35
    v_sub_f32 v35, v30, v32
    v_fmac_f32 v34, v35, v35
    v_sub_f32 v35, v31, v32
    v_fmac_f32 v34, v35, v35
    ds_bpermute_b32 v33, v40, v34
    s_waitcnt lgkmcnt(0)
    v_add_f32 v34, v34, v33
    ds_bpermute_b32 v33, v41, v34
    s_waitcnt lgkmcnt(0)
    v_add_f32 v34, v34, v33
    ds_bpermute_b32 v33, v42, v34
    s_waitcnt lgkmcnt(0)
    v_add_f32 v34, v34, v33
    ds_bpermute_b32 v33, v43, v34
    s_waitcnt lgkmcnt(0)
    v_add_f32 v34, v34, v33
    ds_bpermute_b32 v33, v44, v34
    s_waitcnt lgkmcnt(0)
    v_add_f32 v34, v34, v33
    ds_bpermute_b32 v33, v45, v34
    s_waitcnt lgkmcnt(0)
    v_add_f32 v34, v34, v33
    v_mul_f32 v34, 0x3a800000, v34
    v_cvt_pk_bf16_f32 v36, v32, v34
    v_lshlrev_b32 v32, 16, v36
    v_and_b32 v34, 0xffff0000, v36
    v_add_f32 v34, 0x3727c5ac, v34
    v_cvt_pk_bf16_f32 v36, v34, v34
    v_lshlrev_b32 v34, 16, v36
    v_sqrt_f32 v34, v34
    s_nop 0
    v_cvt_pk_bf16_f32 v36, v34, v34
    v_lshlrev_b32 v34, 16, v36
    v_rcp_f32 v34, v34
    s_nop 0
    v_sub_f32 v16, v16, v32
    v_sub_f32 v17, v17, v32
    v_cvt_pk_bf16_f32 v36, v16, v17
    v_lshlrev_b32 v16, 16, v36
    v_and_b32 v17, 0xffff0000, v36
    v_mul_f32 v16, v16, v34
    v_mul_f32 v17, v17, v34
    v_cvt_pk_bf16_f32 v4, v16, v17
    v_sub_f32 v18, v18, v32
    v_sub_f32 v19, v19, v32
    v_cvt_pk_bf16_f32 v36, v18, v19
    v_lshlrev_b32 v18, 16, v36
    v_and_b32 v19, 0xffff0000, v36
    v_mul_f32 v18, v18, v34
    v_mul_f32 v19, v19, v34
    v_cvt_pk_bf16_f32 v5, v18, v19
    v_sub_f32 v20, v20, v32
    v_sub_f32 v21, v21, v32
    v_cvt_pk_bf16_f32 v36, v20, v21
    v_lshlrev_b32 v20, 16, v36
    v_and_b32 v21, 0xffff0000, v36
    v_mul_f32 v20, v20, v34
    v_mul_f32 v21, v21, v34
    v_cvt_pk_bf16_f32 v6, v20, v21
    v_sub_f32 v22, v22, v32
    v_sub_f32 v23, v23, v32
    v_cvt_pk_bf16_f32 v36, v22, v23
    v_lshlrev_b32 v22, 16, v36
    v_and_b32 v23, 0xffff0000, v36
    v_mul_f32 v22, v22, v34
    v_mul_f32 v23, v23, v34
    v_cvt_pk_bf16_f32 v7, v22, v23
    v_sub_f32 v24, v24, v32
    v_sub_f32 v25, v25, v32
    v_cvt_pk_bf16_f32 v36, v24, v25
    v_lshlrev_b32 v24, 16, v36
    v_and_b32 v25, 0xffff0000, v36
    v_mul_f32 v24, v24, v34
    v_mul_f32 v25, v25, v34
    v_cvt_pk_bf16_f32 v8, v24, v25
    v_sub_f32 v26, v26, v32
    v_sub_f32 v27, v27, v32
    v_cvt_pk_bf16_f32 v36, v26, v27
    v_lshlrev_b32 v26, 16, v36
    v_and_b32 v27, 0xffff0000, v36
    v_mul_f32 v26, v26, v34
    v_mul_f32 v27, v27, v34
    v_cvt_pk_bf16_f32 v9, v26, v27
    v_sub_f32 v28, v28, v32
    v_sub_f32 v29, v29, v32
    v_cvt_pk_bf16_f32 v36, v28, v29
    v_lshlrev_b32 v28, 16, v36
    v_and_b32 v29, 0xffff0000, v36
    v_mul_f32 v28, v28, v34
    v_mul_f32 v29, v29, v34
    v_cvt_pk_bf16_f32 v10, v28, v29
    v_sub_f32 v30, v30, v32
    v_sub_f32 v31, v31, v32
    v_cvt_pk_bf16_f32 v36, v30, v31
    v_lshlrev_b32 v30, 16, v36
    v_and_b32 v31, 0xffff0000, v36
    v_mul_f32 v30, v30, v34
    v_mul_f32 v31, v31, v34
    v_cvt_pk_bf16_f32 v11, v30, v31
    buffer_store_dwordx4 v[4:7], v3, s[12:15], 0 offen
    buffer_store_dwordx4 v[8:11], v3, s[12:15], 0 offen offset:1024
LN_done:
    s_endpgm
.globl gemm1_kernel
.p2align 8
.type gemm1_kernel,@function
gemm1_kernel:
    s_cmp_ge_u32 s2, 1984
    s_cbranch_scc1 G1_done
    s_load_dwordx2 s[4:5], s[0:1], 112
    s_and_b32 s50, s2, 15
    s_lshr_b32 s51, s2, 4
    s_lshr_b32 s52, s51, 5
    s_lshl_b32 s53, s52, 3
    s_add_u32 s53, s53, 16
    s_cmp_eq_u32 s52, 3
    s_cbranch_scc0 G1_sel
    s_mov_b32 s53, 64
G1_sel:
    s_load_dwordx2 s[6:7], s[0:1], s53
    s_load_dwordx2 s[22:23], s[0:1], 72
    s_and_b32 s54, s51, 31
    s_cmp_eq_u32 s52, 3
    s_cbranch_scc1 G1_ffn
    v_lshrrev_b32 v1, 3, v0
    v_and_b32 v2, 7, v0
    s_mov_b32 s30, 2048
    v_mul_lo_u32 v10, v1, s30
    v_lshlrev_b32 v3, 4, v2
    v_add_u32 v10, v10, v3
    v_mul_u32_u24 v12, 144, v1
    v_add_u32 v12, v12, v3
    v_add_u32 v13, 38912, v12
    v_lshrrev_b32 v1, 4, v0
    v_and_b32 v2, 15, v0
    s_mov_b32 s30, 8192
    v_mul_lo_u32 v11, v1, s30
    v_lshlrev_b32 v3, 4, v2
    v_add_u32 v11, v11, v3
    v_mul_u32_u24 v14, 320, v1
    v_add_u32 v14, v14, v3
    v_add_u32 v14, 18432, v14
    v_add_u32 v15, 38912, v14
    v_lshrrev_b32 v1, 6, v0
    v_and_b32 v2, 63, v0
    v_lshrrev_b32 v4, 1, v1
    v_and_b32 v5, 1, v1
    v_and_b32 v6, 31, v2
    v_lshrrev_b32 v7, 5, v2
    v_lshlrev_b32 v8, 6, v4
    v_add_u32 v8, v8, v6
    v_mul_u32_u24 v16, 144, v8
    v_lshlrev_b32 v9, 4, v7
    v_add_u32 v16, v16, v9
    v_add_u32 v17, 38912, v16
    v_lshrrev_b32 v6, 4, v2
    v_and_b32 v7, 15, v2
    v_lshrrev_b32 v8, 2, v7
    v_and_b32 v9, 3, v7
    v_lshrrev_b32 v20, 1, v6
    v_lshlrev_b32 v20, 3, v20
    v_add_u32 v20, v20, v8
    v_mul_u32_u24 v18, 320, v20
    v_and_b32 v21, 1, v6
    v_lshlrev_b32 v21, 4, v21
    v_lshlrev_b32 v22, 2, v9
    v_add_u32 v21, v21, v22
    v_lshlrev_b32 v22, 6, v5
    v_add_u32 v21, v21, v22
    v_lshlrev_b32 v21, 1, v21
    v_add_u32 v18, v18, v21
    v_add_u32 v18, 18432, v18
    v_add_u32 v19, 38912, v18
    s_waitcnt lgkmcnt(0)
    s_mov_b32 s8, s4
    s_and_b32 s9, s5, 0xffff
    s_mov_b32 s10, 4194304
    s_mov_b32 s11, 0x00020000
    s_mov_b32 s12, s6
    s_and_b32 s13, s7, 0xffff
    s_mov_b32 s14, 8388608
    s_mov_b32 s15, 0x00020000
    s_lshl_b32 s55, s50, 18
    s_lshl_b32 s56, s54, 8
    s_add_u32 s40, s55, 0
    s_add_u32 s44, s56, 0
    s_add_u32 s41, s55, 65536
    s_add_u32 s45, s56, 131072
    s_add_u32 s42, s55, 131072
    s_add_u32 s46, s56, 262144
    s_add_u32 s43, s55, 196608
    s_add_u32 s47, s56, 393216
    v_mov_b32 v128, 0
    v_mov_b32 v129, 0
    v_mov_b32 v130, 0
    v_mov_b32 v131, 0
    v_mov_b32 v132, 0
    v_mov_b32 v133, 0
    v_mov_b32 v134, 0
    v_mov_b32 v135, 0
    v_mov_b32 v136, 0
    v_mov_b32 v137, 0
    v_mov_b32 v138, 0
    v_mov_b32 v139, 0
    v_mov_b32 v140, 0
    v_mov_b32 v141, 0
    v_mov_b32 v142, 0
    v_mov_b32 v143, 0
    v_mov_b32 v144, 0
    v_mov_b32 v145, 0
    v_mov_b32 v146, 0
    v_mov_b32 v147, 0
    v_mov_b32 v148, 0
    v_mov_b32 v149, 0
    v_mov_b32 v150, 0
    v_mov_b32 v151, 0
    v_mov_b32 v152, 0
    v_mov_b32 v153, 0
    v_mov_b32 v154, 0
    v_mov_b32 v155, 0
    v_mov_b32 v156, 0
    v_mov_b32 v157, 0
    v_mov_b32 v158, 0
    v_mov_b32 v159, 0
    v_mov_b32 v160, 0
    v_mov_b32 v161, 0
    v_mov_b32 v162, 0
    v_mov_b32 v163, 0
    v_mov_b32 v164, 0
    v_mov_b32 v165, 0
    v_mov_b32 v166, 0
    v_mov_b32 v167, 0
    v_mov_b32 v168, 0
    v_mov_b32 v169, 0
    v_mov_b32 v170, 0
    v_mov_b32 v171, 0
    v_mov_b32 v172, 0
    v_mov_b32 v173, 0
    v_mov_b32 v174, 0
    v_mov_b32 v175, 0
    v_mov_b32 v176, 0
    v_mov_b32 v177, 0
    v_mov_b32 v178, 0
    v_mov_b32 v179, 0
    v_mov_b32 v180, 0
    v_mov_b32 v181, 0
    v_mov_b32 v182, 0
    v_mov_b32 v183, 0
    v_mov_b32 v184, 0
    v_mov_b32 v185, 0
    v_mov_b32 v186, 0
    v_mov_b32 v187, 0
    v_mov_b32 v188, 0
    v_mov_b32 v189, 0
    v_mov_b32 v190, 0
    v_mov_b32 v191, 0
    buffer_load_dwordx4 v[32:35], v10, s[8:11], s40 offen
    buffer_load_dwordx4 v[36:39], v10, s[8:11], s41 offen
    buffer_load_dwordx4 v[40:43], v10, s[8:11], s42 offen
    buffer_load_dwordx4 v[44:47], v10, s[8:11], s43 offen
    buffer_load_dwordx4 v[48:51], v11, s[12:15], s44 offen
    buffer_load_dwordx4 v[52:55], v11, s[12:15], s45 offen
    buffer_load_dwordx4 v[56:59], v11, s[12:15], s46 offen
    buffer_load_dwordx4 v[60:63], v11, s[12:15], s47 offen
    s_add_u32 s40, s40, 128
    s_add_u32 s41, s41, 128
    s_add_u32 s42, s42, 128
    s_add_u32 s43, s43, 128
    s_add_u32 s44, s44, 524288
    s_add_u32 s45, s45, 524288
    s_add_u32 s46, s46, 524288
    s_add_u32 s47, s47, 524288
    s_waitcnt vmcnt(0)
    ds_write_b128 v12, v[32:35] offset:0
    ds_write_b128 v12, v[36:39] offset:4608
    ds_write_b128 v12, v[40:43] offset:9216
    ds_write_b128 v12, v[44:47] offset:13824
    ds_write_b128 v14, v[48:51] offset:0
    ds_write_b128 v14, v[52:55] offset:5120
    ds_write_b128 v14, v[56:59] offset:10240
    ds_write_b128 v14, v[60:63] offset:15360
    s_waitcnt lgkmcnt(0)
    s_barrier
    s_mov_b32 s48, 7
KL_1:
    buffer_load_dwordx4 v[32:35], v10, s[8:11], s40 offen
    buffer_load_dwordx4 v[36:39], v10, s[8:11], s41 offen
    buffer_load_dwordx4 v[40:43], v10, s[8:11], s42 offen
    buffer_load_dwordx4 v[44:47], v10, s[8:11], s43 offen
    buffer_load_dwordx4 v[48:51], v11, s[12:15], s44 offen
    buffer_load_dwordx4 v[52:55], v11, s[12:15], s45 offen
    buffer_load_dwordx4 v[56:59], v11, s[12:15], s46 offen
    buffer_load_dwordx4 v[60:63], v11, s[12:15], s47 offen
    s_add_u32 s40, s40, 128
    s_add_u32 s41, s41, 128
    s_add_u32 s42, s42, 128
    s_add_u32 s43, s43, 128
    s_add_u32 s44, s44, 524288
    s_add_u32 s45, s45, 524288
    s_add_u32 s46, s46, 524288
    s_add_u32 s47, s47, 524288
    ds_read_b128 v[64:67], v16 offset:0
    ds_read_b128 v[68:71], v16 offset:4608
    ds_read_b64_tr_b16 v[72:73], v18 offset:0
    ds_read_b64_tr_b16 v[74:75], v18 offset:1280
    ds_read_b64_tr_b16 v[76:77], v18 offset:64
    ds_read_b64_tr_b16 v[78:79], v18 offset:1344
    ds_read_b128 v[80:83], v16 offset:32
    ds_read_b128 v[84:87], v16 offset:4640
    ds_read_b64_tr_b16 v[88:89], v18 offset:5120
    ds_read_b64_tr_b16 v[90:91], v18 offset:6400
    ds_read_b64_tr_b16 v[92:93], v18 offset:5184
    ds_read_b64_tr_b16 v[94:95], v18 offset:6464
    s_waitcnt lgkmcnt(6)
    v_mfma_f32_32x32x16_bf16 v[128:143], v[72:75], v[64:67], v[128:143]
    v_mfma_f32_32x32x16_bf16 v[144:159], v[72:75], v[68:71], v[144:159]
    v_mfma_f32_32x32x16_bf16 v[160:175], v[76:79], v[64:67], v[160:175]
    v_mfma_f32_32x32x16_bf16 v[176:191], v[76:79], v[68:71], v[176:191]
    ds_read_b128 v[64:67], v16 offset:64
    ds_read_b128 v[68:71], v16 offset:4672
    ds_read_b64_tr_b16 v[72:73], v18 offset:10240
    ds_read_b64_tr_b16 v[74:75], v18 offset:11520
    ds_read_b64_tr_b16 v[76:77], v18 offset:10304
    ds_read_b64_tr_b16 v[78:79], v18 offset:11584
    s_waitcnt lgkmcnt(6)
    v_mfma_f32_32x32x16_bf16 v[128:143], v[88:91], v[80:83], v[128:143]
    v_mfma_f32_32x32x16_bf16 v[144:159], v[88:91], v[84:87], v[144:159]
    v_mfma_f32_32x32x16_bf16 v[160:175], v[92:95], v[80:83], v[160:175]
    v_mfma_f32_32x32x16_bf16 v[176:191], v[92:95], v[84:87], v[176:191]
    ds_read_b128 v[80:83], v16 offset:96
    ds_read_b128 v[84:87], v16 offset:4704
    ds_read_b64_tr_b16 v[88:89], v18 offset:15360
    ds_read_b64_tr_b16 v[90:91], v18 offset:16640
    ds_read_b64_tr_b16 v[92:93], v18 offset:15424
    ds_read_b64_tr_b16 v[94:95], v18 offset:16704
    s_waitcnt lgkmcnt(6)
    v_mfma_f32_32x32x16_bf16 v[128:143], v[72:75], v[64:67], v[128:143]
    v_mfma_f32_32x32x16_bf16 v[144:159], v[72:75], v[68:71], v[144:159]
    v_mfma_f32_32x32x16_bf16 v[160:175], v[76:79], v[64:67], v[160:175]
    v_mfma_f32_32x32x16_bf16 v[176:191], v[76:79], v[68:71], v[176:191]
    s_waitcnt lgkmcnt(0)
    v_mfma_f32_32x32x16_bf16 v[128:143], v[88:91], v[80:83], v[128:143]
    v_mfma_f32_32x32x16_bf16 v[144:159], v[88:91], v[84:87], v[144:159]
    v_mfma_f32_32x32x16_bf16 v[160:175], v[92:95], v[80:83], v[160:175]
    v_mfma_f32_32x32x16_bf16 v[176:191], v[92:95], v[84:87], v[176:191]
    s_waitcnt vmcnt(0)
    ds_write_b128 v13, v[32:35] offset:0
    ds_write_b128 v13, v[36:39] offset:4608
    ds_write_b128 v13, v[40:43] offset:9216
    ds_write_b128 v13, v[44:47] offset:13824
    ds_write_b128 v15, v[48:51] offset:0
    ds_write_b128 v15, v[52:55] offset:5120
    ds_write_b128 v15, v[56:59] offset:10240
    ds_write_b128 v15, v[60:63] offset:15360
    s_waitcnt lgkmcnt(0)
    s_barrier
    s_cmp_eq_u32 s48, 0
    s_cbranch_scc1 KS_2
    buffer_load_dwordx4 v[32:35], v10, s[8:11], s40 offen
    buffer_load_dwordx4 v[36:39], v10, s[8:11], s41 offen
    buffer_load_dwordx4 v[40:43], v10, s[8:11], s42 offen
    buffer_load_dwordx4 v[44:47], v10, s[8:11], s43 offen
    buffer_load_dwordx4 v[48:51], v11, s[12:15], s44 offen
    buffer_load_dwordx4 v[52:55], v11, s[12:15], s45 offen
    buffer_load_dwordx4 v[56:59], v11, s[12:15], s46 offen
    buffer_load_dwordx4 v[60:63], v11, s[12:15], s47 offen
    s_add_u32 s40, s40, 128
    s_add_u32 s41, s41, 128
    s_add_u32 s42, s42, 128
    s_add_u32 s43, s43, 128
    s_add_u32 s44, s44, 524288
    s_add_u32 s45, s45, 524288
    s_add_u32 s46, s46, 524288
    s_add_u32 s47, s47, 524288
KS_2:
    ds_read_b128 v[64:67], v17 offset:0
    ds_read_b128 v[68:71], v17 offset:4608
    ds_read_b64_tr_b16 v[72:73], v19 offset:0
    ds_read_b64_tr_b16 v[74:75], v19 offset:1280
    ds_read_b64_tr_b16 v[76:77], v19 offset:64
    ds_read_b64_tr_b16 v[78:79], v19 offset:1344
    ds_read_b128 v[80:83], v17 offset:32
    ds_read_b128 v[84:87], v17 offset:4640
    ds_read_b64_tr_b16 v[88:89], v19 offset:5120
    ds_read_b64_tr_b16 v[90:91], v19 offset:6400
    ds_read_b64_tr_b16 v[92:93], v19 offset:5184
    ds_read_b64_tr_b16 v[94:95], v19 offset:6464
    s_waitcnt lgkmcnt(6)
    v_mfma_f32_32x32x16_bf16 v[128:143], v[72:75], v[64:67], v[128:143]
    v_mfma_f32_32x32x16_bf16 v[144:159], v[72:75], v[68:71], v[144:159]
    v_mfma_f32_32x32x16_bf16 v[160:175], v[76:79], v[64:67], v[160:175]
    v_mfma_f32_32x32x16_bf16 v[176:191], v[76:79], v[68:71], v[176:191]
    ds_read_b128 v[64:67], v17 offset:64
    ds_read_b128 v[68:71], v17 offset:4672
    ds_read_b64_tr_b16 v[72:73], v19 offset:10240
    ds_read_b64_tr_b16 v[74:75], v19 offset:11520
    ds_read_b64_tr_b16 v[76:77], v19 offset:10304
    ds_read_b64_tr_b16 v[78:79], v19 offset:11584
    s_waitcnt lgkmcnt(6)
    v_mfma_f32_32x32x16_bf16 v[128:143], v[88:91], v[80:83], v[128:143]
    v_mfma_f32_32x32x16_bf16 v[144:159], v[88:91], v[84:87], v[144:159]
    v_mfma_f32_32x32x16_bf16 v[160:175], v[92:95], v[80:83], v[160:175]
    v_mfma_f32_32x32x16_bf16 v[176:191], v[92:95], v[84:87], v[176:191]
    ds_read_b128 v[80:83], v17 offset:96
    ds_read_b128 v[84:87], v17 offset:4704
    ds_read_b64_tr_b16 v[88:89], v19 offset:15360
    ds_read_b64_tr_b16 v[90:91], v19 offset:16640
    ds_read_b64_tr_b16 v[92:93], v19 offset:15424
    ds_read_b64_tr_b16 v[94:95], v19 offset:16704
    s_waitcnt lgkmcnt(6)
    v_mfma_f32_32x32x16_bf16 v[128:143], v[72:75], v[64:67], v[128:143]
    v_mfma_f32_32x32x16_bf16 v[144:159], v[72:75], v[68:71], v[144:159]
    v_mfma_f32_32x32x16_bf16 v[160:175], v[76:79], v[64:67], v[160:175]
    v_mfma_f32_32x32x16_bf16 v[176:191], v[76:79], v[68:71], v[176:191]
    s_waitcnt lgkmcnt(0)
    v_mfma_f32_32x32x16_bf16 v[128:143], v[88:91], v[80:83], v[128:143]
    v_mfma_f32_32x32x16_bf16 v[144:159], v[88:91], v[84:87], v[144:159]
    v_mfma_f32_32x32x16_bf16 v[160:175], v[92:95], v[80:83], v[160:175]
    v_mfma_f32_32x32x16_bf16 v[176:191], v[92:95], v[84:87], v[176:191]
    s_cmp_eq_u32 s48, 0
    s_cbranch_scc1 KE_3
    s_waitcnt vmcnt(0)
    ds_write_b128 v12, v[32:35] offset:0
    ds_write_b128 v12, v[36:39] offset:4608
    ds_write_b128 v12, v[40:43] offset:9216
    ds_write_b128 v12, v[44:47] offset:13824
    ds_write_b128 v14, v[48:51] offset:0
    ds_write_b128 v14, v[52:55] offset:5120
    ds_write_b128 v14, v[56:59] offset:10240
    ds_write_b128 v14, v[60:63] offset:15360
    s_waitcnt lgkmcnt(0)
    s_barrier
    s_sub_u32 s48, s48, 1
    s_branch KL_1
KE_3:
    s_barrier
    v_lshrrev_b32 v1, 6, v0
    v_and_b32 v2, 63, v0
    v_lshrrev_b32 v4, 1, v1
    v_and_b32 v5, 1, v1
    v_and_b32 v6, 31, v2
    v_lshrrev_b32 v7, 5, v2
    v_lshlrev_b32 v20, 6, v4
    v_add_u32 v20, v20, v6
    v_lshlrev_b32 v21, 6, v5
    v_lshlrev_b32 v7, 2, v7
    v_add_u32 v21, v21, v7
    s_lshl_b32 s57, s52, 24
    s_add_u32 s57, s57, 4194304
    s_add_u32 s16, s4, s57
    s_addc_u32 s17, s5, 0
    s_mov_b32 s16, s16
    s_and_b32 s17, s17, 0xffff
    s_mov_b32 s18, 16777216
    s_mov_b32 s19, 0x00020000
    s_lshl_b32 s55, s50, 7
    v_add_u32 v20, s55, v20
    s_lshl_b32 s56, s54, 7
    v_add_u32 v21, s56, v21
    v_lshlrev_b32 v20, 13, v20
    v_lshlrev_b32 v21, 1, v21
    v_add_u32 v22, v20, v21
    s_nop 8
    v_cvt_pk_bf16_f32 v24, v128, v129
    v_cvt_pk_bf16_f32 v25, v130, v131
    v_add_u32 v23, 0, v22
    buffer_store_dwordx2 v[24:25], v23, s[16:19], 0 offen
    v_cvt_pk_bf16_f32 v24, v132, v133
    v_cvt_pk_bf16_f32 v25, v134, v135
    v_add_u32 v23, 16, v22
    buffer_store_dwordx2 v[24:25], v23, s[16:19], 0 offen
    v_cvt_pk_bf16_f32 v24, v136, v137
    v_cvt_pk_bf16_f32 v25, v138, v139
    v_add_u32 v23, 32, v22
    buffer_store_dwordx2 v[24:25], v23, s[16:19], 0 offen
    v_cvt_pk_bf16_f32 v24, v140, v141
    v_cvt_pk_bf16_f32 v25, v142, v143
    v_add_u32 v23, 48, v22
    buffer_store_dwordx2 v[24:25], v23, s[16:19], 0 offen
    v_cvt_pk_bf16_f32 v24, v144, v145
    v_cvt_pk_bf16_f32 v25, v146, v147
    v_add_u32 v23, 262144, v22
    buffer_store_dwordx2 v[24:25], v23, s[16:19], 0 offen
    v_cvt_pk_bf16_f32 v24, v148, v149
    v_cvt_pk_bf16_f32 v25, v150, v151
    v_add_u32 v23, 262160, v22
    buffer_store_dwordx2 v[24:25], v23, s[16:19], 0 offen
    v_cvt_pk_bf16_f32 v24, v152, v153
    v_cvt_pk_bf16_f32 v25, v154, v155
    v_add_u32 v23, 262176, v22
    buffer_store_dwordx2 v[24:25], v23, s[16:19], 0 offen
    v_cvt_pk_bf16_f32 v24, v156, v157
    v_cvt_pk_bf16_f32 v25, v158, v159
    v_add_u32 v23, 262192, v22
    buffer_store_dwordx2 v[24:25], v23, s[16:19], 0 offen
    v_cvt_pk_bf16_f32 v24, v160, v161
    v_cvt_pk_bf16_f32 v25, v162, v163
    v_add_u32 v23, 64, v22
    buffer_store_dwordx2 v[24:25], v23, s[16:19], 0 offen
    v_cvt_pk_bf16_f32 v24, v164, v165
    v_cvt_pk_bf16_f32 v25, v166, v167
    v_add_u32 v23, 80, v22
    buffer_store_dwordx2 v[24:25], v23, s[16:19], 0 offen
    v_cvt_pk_bf16_f32 v24, v168, v169
    v_cvt_pk_bf16_f32 v25, v170, v171
    v_add_u32 v23, 96, v22
    buffer_store_dwordx2 v[24:25], v23, s[16:19], 0 offen
    v_cvt_pk_bf16_f32 v24, v172, v173
    v_cvt_pk_bf16_f32 v25, v174, v175
    v_add_u32 v23, 112, v22
    buffer_store_dwordx2 v[24:25], v23, s[16:19], 0 offen
    v_cvt_pk_bf16_f32 v24, v176, v177
    v_cvt_pk_bf16_f32 v25, v178, v179
    v_add_u32 v23, 262208, v22
    buffer_store_dwordx2 v[24:25], v23, s[16:19], 0 offen
    v_cvt_pk_bf16_f32 v24, v180, v181
    v_cvt_pk_bf16_f32 v25, v182, v183
    v_add_u32 v23, 262224, v22
    buffer_store_dwordx2 v[24:25], v23, s[16:19], 0 offen
    v_cvt_pk_bf16_f32 v24, v184, v185
    v_cvt_pk_bf16_f32 v25, v186, v187
    v_add_u32 v23, 262240, v22
    buffer_store_dwordx2 v[24:25], v23, s[16:19], 0 offen
    v_cvt_pk_bf16_f32 v24, v188, v189
    v_cvt_pk_bf16_f32 v25, v190, v191
    v_add_u32 v23, 262256, v22
    buffer_store_dwordx2 v[24:25], v23, s[16:19], 0 offen
    s_branch G1_done
G1_ffn:
    v_lshrrev_b32 v1, 3, v0
    v_and_b32 v2, 7, v0
    s_mov_b32 s30, 2048
    v_mul_lo_u32 v10, v1, s30
    v_lshlrev_b32 v3, 4, v2
    v_add_u32 v10, v10, v3
    v_mul_u32_u24 v12, 144, v1
    v_add_u32 v12, v12, v3
    v_add_u32 v13, 38912, v12
    v_lshrrev_b32 v1, 4, v0
    v_and_b32 v2, 15, v0
    s_mov_b32 s30, 7168
    v_mul_lo_u32 v11, v1, s30
    v_lshlrev_b32 v3, 4, v2
    v_add_u32 v11, v11, v3
    v_mul_u32_u24 v14, 320, v1
    v_add_u32 v14, v14, v3
    v_add_u32 v14, 18432, v14
    v_add_u32 v15, 38912, v14
    v_lshrrev_b32 v1, 6, v0
    v_and_b32 v2, 63, v0
    v_lshrrev_b32 v4, 1, v1
    v_and_b32 v5, 1, v1
    v_and_b32 v6, 31, v2
    v_lshrrev_b32 v7, 5, v2
    v_lshlrev_b32 v8, 6, v4
    v_add_u32 v8, v8, v6
    v_mul_u32_u24 v16, 144, v8
    v_lshlrev_b32 v9, 4, v7
    v_add_u32 v16, v16, v9
    v_add_u32 v17, 38912, v16
    v_lshrrev_b32 v6, 4, v2
    v_and_b32 v7, 15, v2
    v_lshrrev_b32 v8, 2, v7
    v_and_b32 v9, 3, v7
    v_lshrrev_b32 v20, 1, v6
    v_lshlrev_b32 v20, 3, v20
    v_add_u32 v20, v20, v8
    v_mul_u32_u24 v18, 320, v20
    v_and_b32 v21, 1, v6
    v_lshlrev_b32 v21, 4, v21
    v_lshlrev_b32 v22, 2, v9
    v_add_u32 v21, v21, v22
    v_lshlrev_b32 v22, 6, v5
    v_add_u32 v21, v21, v22
    v_lshlrev_b32 v21, 1, v21
    v_add_u32 v18, v18, v21
    v_add_u32 v18, 18432, v18
    v_add_u32 v19, 38912, v18
    s_waitcnt lgkmcnt(0)
    s_mov_b32 s8, s4
    s_and_b32 s9, s5, 0xffff
    s_mov_b32 s10, 4194304
    s_mov_b32 s11, 0x00020000
    s_mov_b32 s12, s6
    s_and_b32 s13, s7, 0xffff
    s_mov_b32 s14, 7340032
    s_mov_b32 s15, 0x00020000
    s_lshl_b32 s55, s50, 18
    s_lshl_b32 s56, s54, 8
    s_add_u32 s40, s55, 0
    s_add_u32 s44, s56, 0
    s_add_u32 s41, s55, 65536
    s_add_u32 s45, s56, 114688
    s_add_u32 s42, s55, 131072
    s_add_u32 s46, s56, 229376
    s_add_u32 s43, s55, 196608
    s_add_u32 s47, s56, 344064
    v_mov_b32 v128, 0
    v_mov_b32 v129, 0
    v_mov_b32 v130, 0
    v_mov_b32 v131, 0
    v_mov_b32 v132, 0
    v_mov_b32 v133, 0
    v_mov_b32 v134, 0
    v_mov_b32 v135, 0
    v_mov_b32 v136, 0
    v_mov_b32 v137, 0
    v_mov_b32 v138, 0
    v_mov_b32 v139, 0
    v_mov_b32 v140, 0
    v_mov_b32 v141, 0
    v_mov_b32 v142, 0
    v_mov_b32 v143, 0
    v_mov_b32 v144, 0
    v_mov_b32 v145, 0
    v_mov_b32 v146, 0
    v_mov_b32 v147, 0
    v_mov_b32 v148, 0
    v_mov_b32 v149, 0
    v_mov_b32 v150, 0
    v_mov_b32 v151, 0
    v_mov_b32 v152, 0
    v_mov_b32 v153, 0
    v_mov_b32 v154, 0
    v_mov_b32 v155, 0
    v_mov_b32 v156, 0
    v_mov_b32 v157, 0
    v_mov_b32 v158, 0
    v_mov_b32 v159, 0
    v_mov_b32 v160, 0
    v_mov_b32 v161, 0
    v_mov_b32 v162, 0
    v_mov_b32 v163, 0
    v_mov_b32 v164, 0
    v_mov_b32 v165, 0
    v_mov_b32 v166, 0
    v_mov_b32 v167, 0
    v_mov_b32 v168, 0
    v_mov_b32 v169, 0
    v_mov_b32 v170, 0
    v_mov_b32 v171, 0
    v_mov_b32 v172, 0
    v_mov_b32 v173, 0
    v_mov_b32 v174, 0
    v_mov_b32 v175, 0
    v_mov_b32 v176, 0
    v_mov_b32 v177, 0
    v_mov_b32 v178, 0
    v_mov_b32 v179, 0
    v_mov_b32 v180, 0
    v_mov_b32 v181, 0
    v_mov_b32 v182, 0
    v_mov_b32 v183, 0
    v_mov_b32 v184, 0
    v_mov_b32 v185, 0
    v_mov_b32 v186, 0
    v_mov_b32 v187, 0
    v_mov_b32 v188, 0
    v_mov_b32 v189, 0
    v_mov_b32 v190, 0
    v_mov_b32 v191, 0
    buffer_load_dwordx4 v[32:35], v10, s[8:11], s40 offen
    buffer_load_dwordx4 v[36:39], v10, s[8:11], s41 offen
    buffer_load_dwordx4 v[40:43], v10, s[8:11], s42 offen
    buffer_load_dwordx4 v[44:47], v10, s[8:11], s43 offen
    buffer_load_dwordx4 v[48:51], v11, s[12:15], s44 offen
    buffer_load_dwordx4 v[52:55], v11, s[12:15], s45 offen
    buffer_load_dwordx4 v[56:59], v11, s[12:15], s46 offen
    buffer_load_dwordx4 v[60:63], v11, s[12:15], s47 offen
    s_add_u32 s40, s40, 128
    s_add_u32 s41, s41, 128
    s_add_u32 s42, s42, 128
    s_add_u32 s43, s43, 128
    s_add_u32 s44, s44, 458752
    s_add_u32 s45, s45, 458752
    s_add_u32 s46, s46, 458752
    s_add_u32 s47, s47, 458752
    s_waitcnt vmcnt(0)
    ds_write_b128 v12, v[32:35] offset:0
    ds_write_b128 v12, v[36:39] offset:4608
    ds_write_b128 v12, v[40:43] offset:9216
    ds_write_b128 v12, v[44:47] offset:13824
    ds_write_b128 v14, v[48:51] offset:0
    ds_write_b128 v14, v[52:55] offset:5120
    ds_write_b128 v14, v[56:59] offset:10240
    ds_write_b128 v14, v[60:63] offset:15360
    s_waitcnt lgkmcnt(0)
    s_barrier
    s_mov_b32 s48, 7
KL_4:
    buffer_load_dwordx4 v[32:35], v10, s[8:11], s40 offen
    buffer_load_dwordx4 v[36:39], v10, s[8:11], s41 offen
    buffer_load_dwordx4 v[40:43], v10, s[8:11], s42 offen
    buffer_load_dwordx4 v[44:47], v10, s[8:11], s43 offen
    buffer_load_dwordx4 v[48:51], v11, s[12:15], s44 offen
    buffer_load_dwordx4 v[52:55], v11, s[12:15], s45 offen
    buffer_load_dwordx4 v[56:59], v11, s[12:15], s46 offen
    buffer_load_dwordx4 v[60:63], v11, s[12:15], s47 offen
    s_add_u32 s40, s40, 128
    s_add_u32 s41, s41, 128
    s_add_u32 s42, s42, 128
    s_add_u32 s43, s43, 128
    s_add_u32 s44, s44, 458752
    s_add_u32 s45, s45, 458752
    s_add_u32 s46, s46, 458752
    s_add_u32 s47, s47, 458752
    ds_read_b128 v[64:67], v16 offset:0
    ds_read_b128 v[68:71], v16 offset:4608
    ds_read_b64_tr_b16 v[72:73], v18 offset:0
    ds_read_b64_tr_b16 v[74:75], v18 offset:1280
    ds_read_b64_tr_b16 v[76:77], v18 offset:64
    ds_read_b64_tr_b16 v[78:79], v18 offset:1344
    ds_read_b128 v[80:83], v16 offset:32
    ds_read_b128 v[84:87], v16 offset:4640
    ds_read_b64_tr_b16 v[88:89], v18 offset:5120
    ds_read_b64_tr_b16 v[90:91], v18 offset:6400
    ds_read_b64_tr_b16 v[92:93], v18 offset:5184
    ds_read_b64_tr_b16 v[94:95], v18 offset:6464
    s_waitcnt lgkmcnt(6)
    v_mfma_f32_32x32x16_bf16 v[128:143], v[72:75], v[64:67], v[128:143]
    v_mfma_f32_32x32x16_bf16 v[144:159], v[72:75], v[68:71], v[144:159]
    v_mfma_f32_32x32x16_bf16 v[160:175], v[76:79], v[64:67], v[160:175]
    v_mfma_f32_32x32x16_bf16 v[176:191], v[76:79], v[68:71], v[176:191]
    ds_read_b128 v[64:67], v16 offset:64
    ds_read_b128 v[68:71], v16 offset:4672
    ds_read_b64_tr_b16 v[72:73], v18 offset:10240
    ds_read_b64_tr_b16 v[74:75], v18 offset:11520
    ds_read_b64_tr_b16 v[76:77], v18 offset:10304
    ds_read_b64_tr_b16 v[78:79], v18 offset:11584
    s_waitcnt lgkmcnt(6)
    v_mfma_f32_32x32x16_bf16 v[128:143], v[88:91], v[80:83], v[128:143]
    v_mfma_f32_32x32x16_bf16 v[144:159], v[88:91], v[84:87], v[144:159]
    v_mfma_f32_32x32x16_bf16 v[160:175], v[92:95], v[80:83], v[160:175]
    v_mfma_f32_32x32x16_bf16 v[176:191], v[92:95], v[84:87], v[176:191]
    ds_read_b128 v[80:83], v16 offset:96
    ds_read_b128 v[84:87], v16 offset:4704
    ds_read_b64_tr_b16 v[88:89], v18 offset:15360
    ds_read_b64_tr_b16 v[90:91], v18 offset:16640
    ds_read_b64_tr_b16 v[92:93], v18 offset:15424
    ds_read_b64_tr_b16 v[94:95], v18 offset:16704
    s_waitcnt lgkmcnt(6)
    v_mfma_f32_32x32x16_bf16 v[128:143], v[72:75], v[64:67], v[128:143]
    v_mfma_f32_32x32x16_bf16 v[144:159], v[72:75], v[68:71], v[144:159]
    v_mfma_f32_32x32x16_bf16 v[160:175], v[76:79], v[64:67], v[160:175]
    v_mfma_f32_32x32x16_bf16 v[176:191], v[76:79], v[68:71], v[176:191]
    s_waitcnt lgkmcnt(0)
    v_mfma_f32_32x32x16_bf16 v[128:143], v[88:91], v[80:83], v[128:143]
    v_mfma_f32_32x32x16_bf16 v[144:159], v[88:91], v[84:87], v[144:159]
    v_mfma_f32_32x32x16_bf16 v[160:175], v[92:95], v[80:83], v[160:175]
    v_mfma_f32_32x32x16_bf16 v[176:191], v[92:95], v[84:87], v[176:191]
    s_waitcnt vmcnt(0)
    ds_write_b128 v13, v[32:35] offset:0
    ds_write_b128 v13, v[36:39] offset:4608
    ds_write_b128 v13, v[40:43] offset:9216
    ds_write_b128 v13, v[44:47] offset:13824
    ds_write_b128 v15, v[48:51] offset:0
    ds_write_b128 v15, v[52:55] offset:5120
    ds_write_b128 v15, v[56:59] offset:10240
    ds_write_b128 v15, v[60:63] offset:15360
    s_waitcnt lgkmcnt(0)
    s_barrier
    s_cmp_eq_u32 s48, 0
    s_cbranch_scc1 KS_5
    buffer_load_dwordx4 v[32:35], v10, s[8:11], s40 offen
    buffer_load_dwordx4 v[36:39], v10, s[8:11], s41 offen
    buffer_load_dwordx4 v[40:43], v10, s[8:11], s42 offen
    buffer_load_dwordx4 v[44:47], v10, s[8:11], s43 offen
    buffer_load_dwordx4 v[48:51], v11, s[12:15], s44 offen
    buffer_load_dwordx4 v[52:55], v11, s[12:15], s45 offen
    buffer_load_dwordx4 v[56:59], v11, s[12:15], s46 offen
    buffer_load_dwordx4 v[60:63], v11, s[12:15], s47 offen
    s_add_u32 s40, s40, 128
    s_add_u32 s41, s41, 128
    s_add_u32 s42, s42, 128
    s_add_u32 s43, s43, 128
    s_add_u32 s44, s44, 458752
    s_add_u32 s45, s45, 458752
    s_add_u32 s46, s46, 458752
    s_add_u32 s47, s47, 458752
KS_5:
    ds_read_b128 v[64:67], v17 offset:0
    ds_read_b128 v[68:71], v17 offset:4608
    ds_read_b64_tr_b16 v[72:73], v19 offset:0
    ds_read_b64_tr_b16 v[74:75], v19 offset:1280
    ds_read_b64_tr_b16 v[76:77], v19 offset:64
    ds_read_b64_tr_b16 v[78:79], v19 offset:1344
    ds_read_b128 v[80:83], v17 offset:32
    ds_read_b128 v[84:87], v17 offset:4640
    ds_read_b64_tr_b16 v[88:89], v19 offset:5120
    ds_read_b64_tr_b16 v[90:91], v19 offset:6400
    ds_read_b64_tr_b16 v[92:93], v19 offset:5184
    ds_read_b64_tr_b16 v[94:95], v19 offset:6464
    s_waitcnt lgkmcnt(6)
    v_mfma_f32_32x32x16_bf16 v[128:143], v[72:75], v[64:67], v[128:143]
    v_mfma_f32_32x32x16_bf16 v[144:159], v[72:75], v[68:71], v[144:159]
    v_mfma_f32_32x32x16_bf16 v[160:175], v[76:79], v[64:67], v[160:175]
    v_mfma_f32_32x32x16_bf16 v[176:191], v[76:79], v[68:71], v[176:191]
    ds_read_b128 v[64:67], v17 offset:64
    ds_read_b128 v[68:71], v17 offset:4672
    ds_read_b64_tr_b16 v[72:73], v19 offset:10240
    ds_read_b64_tr_b16 v[74:75], v19 offset:11520
    ds_read_b64_tr_b16 v[76:77], v19 offset:10304
    ds_read_b64_tr_b16 v[78:79], v19 offset:11584
    s_waitcnt lgkmcnt(6)
    v_mfma_f32_32x32x16_bf16 v[128:143], v[88:91], v[80:83], v[128:143]
    v_mfma_f32_32x32x16_bf16 v[144:159], v[88:91], v[84:87], v[144:159]
    v_mfma_f32_32x32x16_bf16 v[160:175], v[92:95], v[80:83], v[160:175]
    v_mfma_f32_32x32x16_bf16 v[176:191], v[92:95], v[84:87], v[176:191]
    ds_read_b128 v[80:83], v17 offset:96
    ds_read_b128 v[84:87], v17 offset:4704
    ds_read_b64_tr_b16 v[88:89], v19 offset:15360
    ds_read_b64_tr_b16 v[90:91], v19 offset:16640
    ds_read_b64_tr_b16 v[92:93], v19 offset:15424
    ds_read_b64_tr_b16 v[94:95], v19 offset:16704
    s_waitcnt lgkmcnt(6)
    v_mfma_f32_32x32x16_bf16 v[128:143], v[72:75], v[64:67], v[128:143]
    v_mfma_f32_32x32x16_bf16 v[144:159], v[72:75], v[68:71], v[144:159]
    v_mfma_f32_32x32x16_bf16 v[160:175], v[76:79], v[64:67], v[160:175]
    v_mfma_f32_32x32x16_bf16 v[176:191], v[76:79], v[68:71], v[176:191]
    s_waitcnt lgkmcnt(0)
    v_mfma_f32_32x32x16_bf16 v[128:143], v[88:91], v[80:83], v[128:143]
    v_mfma_f32_32x32x16_bf16 v[144:159], v[88:91], v[84:87], v[144:159]
    v_mfma_f32_32x32x16_bf16 v[160:175], v[92:95], v[80:83], v[160:175]
    v_mfma_f32_32x32x16_bf16 v[176:191], v[92:95], v[84:87], v[176:191]
    s_cmp_eq_u32 s48, 0
    s_cbranch_scc1 KE_6
    s_waitcnt vmcnt(0)
    ds_write_b128 v12, v[32:35] offset:0
    ds_write_b128 v12, v[36:39] offset:4608
    ds_write_b128 v12, v[40:43] offset:9216
    ds_write_b128 v12, v[44:47] offset:13824
    ds_write_b128 v14, v[48:51] offset:0
    ds_write_b128 v14, v[52:55] offset:5120
    ds_write_b128 v14, v[56:59] offset:10240
    ds_write_b128 v14, v[60:63] offset:15360
    s_waitcnt lgkmcnt(0)
    s_barrier
    s_sub_u32 s48, s48, 1
    s_branch KL_4
KE_6:
    s_barrier
    v_lshrrev_b32 v1, 6, v0
    v_and_b32 v2, 63, v0
    v_lshrrev_b32 v4, 1, v1
    v_and_b32 v5, 1, v1
    v_and_b32 v6, 31, v2
    v_lshrrev_b32 v7, 5, v2
    v_lshlrev_b32 v20, 6, v4
    v_add_u32 v20, v20, v6
    v_lshlrev_b32 v21, 6, v5
    v_lshlrev_b32 v7, 2, v7
    v_add_u32 v21, v21, v7
    s_add_u32 s16, s4, 54525952
    s_addc_u32 s17, s5, 0
    s_mov_b32 s16, s16
    s_and_b32 s17, s17, 0xffff
    s_mov_b32 s18, 14680064
    s_mov_b32 s19, 0x00020000
    s_mov_b32 s24, s22
    s_and_b32 s25, s23, 0xffff
    s_mov_b32 s26, 7168
    s_mov_b32 s27, 0x00020000
    s_lshl_b32 s55, s50, 7
    v_add_u32 v20, s55, v20
    s_lshl_b32 s56, s54, 7
    v_add_u32 v21, s56, v21
    s_mov_b32 s58, 7168
    s_mov_b32 s59, 0x3d372713
    v_mul_lo_u32 v20, v20, s58
    v_lshlrev_b32 v21, 1, v21
    v_add_u32 v22, v20, v21
    buffer_load_dwordx2 v[32:33], v21, s[24:27], 0 offen offset:0
    buffer_load_dwordx2 v[36:37], v21, s[24:27], 0 offen offset:16
    buffer_load_dwordx2 v[40:41], v21, s[24:27], 0 offen offset:32
    buffer_load_dwordx2 v[44:45], v21, s[24:27], 0 offen offset:48
    buffer_load_dwordx2 v[48:49], v21, s[24:27], 0 offen offset:64
    buffer_load_dwordx2 v[52:53], v21, s[24:27], 0 offen offset:80
    buffer_load_dwordx2 v[56:57], v21, s[24:27], 0 offen offset:96
    buffer_load_dwordx2 v[60:61], v21, s[24:27], 0 offen offset:112
    s_waitcnt vmcnt(0)
    v_and_b32 v35, 0xffff0000, v33
    v_lshlrev_b32 v34, 16, v33
    v_and_b32 v33, 0xffff0000, v32
    v_lshlrev_b32 v32, 16, v32
    v_and_b32 v39, 0xffff0000, v37
    v_lshlrev_b32 v38, 16, v37
    v_and_b32 v37, 0xffff0000, v36
    v_lshlrev_b32 v36, 16, v36
    v_and_b32 v43, 0xffff0000, v41
    v_lshlrev_b32 v42, 16, v41
    v_and_b32 v41, 0xffff0000, v40
    v_lshlrev_b32 v40, 16, v40
    v_and_b32 v47, 0xffff0000, v45
    v_lshlrev_b32 v46, 16, v45
    v_and_b32 v45, 0xffff0000, v44
    v_lshlrev_b32 v44, 16, v44
    v_and_b32 v51, 0xffff0000, v49
    v_lshlrev_b32 v50, 16, v49
    v_and_b32 v49, 0xffff0000, v48
    v_lshlrev_b32 v48, 16, v48
    v_and_b32 v55, 0xffff0000, v53
    v_lshlrev_b32 v54, 16, v53
    v_and_b32 v53, 0xffff0000, v52
    v_lshlrev_b32 v52, 16, v52
    v_and_b32 v59, 0xffff0000, v57
    v_lshlrev_b32 v58, 16, v57
    v_and_b32 v57, 0xffff0000, v56
    v_lshlrev_b32 v56, 16, v56
    v_and_b32 v63, 0xffff0000, v61
    v_lshlrev_b32 v62, 16, v61
    v_and_b32 v61, 0xffff0000, v60
    v_lshlrev_b32 v60, 16, v60
    s_nop 4
    v_cvt_pk_bf16_f32 v24, v128, v129
    v_lshlrev_b32 v128, 16, v24
    v_and_b32 v129, 0xffff0000, v24
    v_add_f32 v128, v128, v32
    v_add_f32 v129, v129, v33
    v_cvt_pk_bf16_f32 v24, v128, v129
    v_lshlrev_b32 v128, 16, v24
    v_and_b32 v129, 0xffff0000, v24
    v_mul_f32 v26, v128, v128
    v_fma_f32 v26, v26, s59, 1.0
    v_mul_f32 v26, v26, v128
    v_mul_f32 v26, 0x40135761, v26
    v_exp_f32 v26, v26
    s_nop 0
    v_add_f32 v26, 1.0, v26
    v_rcp_f32 v26, v26
    s_nop 0
    v_fma_f32 v26, v26, -2.0, 2.0
    v_mul_f32 v27, 0.5, v128
    v_mul_f32 v128, v27, v26
    v_mul_f32 v26, v129, v129
    v_fma_f32 v26, v26, s59, 1.0
    v_mul_f32 v26, v26, v129
    v_mul_f32 v26, 0x40135761, v26
    v_exp_f32 v26, v26
    s_nop 0
    v_add_f32 v26, 1.0, v26
    v_rcp_f32 v26, v26
    s_nop 0
    v_fma_f32 v26, v26, -2.0, 2.0
    v_mul_f32 v27, 0.5, v129
    v_mul_f32 v129, v27, v26
    v_cvt_pk_bf16_f32 v24, v130, v131
    v_lshlrev_b32 v130, 16, v24
    v_and_b32 v131, 0xffff0000, v24
    v_add_f32 v130, v130, v34
    v_add_f32 v131, v131, v35
    v_cvt_pk_bf16_f32 v24, v130, v131
    v_lshlrev_b32 v130, 16, v24
    v_and_b32 v131, 0xffff0000, v24
    v_mul_f32 v26, v130, v130
    v_fma_f32 v26, v26, s59, 1.0
    v_mul_f32 v26, v26, v130
    v_mul_f32 v26, 0x40135761, v26
    v_exp_f32 v26, v26
    s_nop 0
    v_add_f32 v26, 1.0, v26
    v_rcp_f32 v26, v26
    s_nop 0
    v_fma_f32 v26, v26, -2.0, 2.0
    v_mul_f32 v27, 0.5, v130
    v_mul_f32 v130, v27, v26
    v_mul_f32 v26, v131, v131
    v_fma_f32 v26, v26, s59, 1.0
    v_mul_f32 v26, v26, v131
    v_mul_f32 v26, 0x40135761, v26
    v_exp_f32 v26, v26
    s_nop 0
    v_add_f32 v26, 1.0, v26
    v_rcp_f32 v26, v26
    s_nop 0
    v_fma_f32 v26, v26, -2.0, 2.0
    v_mul_f32 v27, 0.5, v131
    v_mul_f32 v131, v27, v26
    v_cvt_pk_bf16_f32 v24, v128, v129
    v_cvt_pk_bf16_f32 v25, v130, v131
    v_add_u32 v23, 0, v22
    buffer_store_dwordx2 v[24:25], v23, s[16:19], 0 offen
    v_cvt_pk_bf16_f32 v24, v132, v133
    v_lshlrev_b32 v132, 16, v24
    v_and_b32 v133, 0xffff0000, v24
    v_add_f32 v132, v132, v36
    v_add_f32 v133, v133, v37
    v_cvt_pk_bf16_f32 v24, v132, v133
    v_lshlrev_b32 v132, 16, v24
    v_and_b32 v133, 0xffff0000, v24
    v_mul_f32 v26, v132, v132
    v_fma_f32 v26, v26, s59, 1.0
    v_mul_f32 v26, v26, v132
    v_mul_f32 v26, 0x40135761, v26
    v_exp_f32 v26, v26
    s_nop 0
    v_add_f32 v26, 1.0, v26
    v_rcp_f32 v26, v26
    s_nop 0
    v_fma_f32 v26, v26, -2.0, 2.0
    v_mul_f32 v27, 0.5, v132
    v_mul_f32 v132, v27, v26
    v_mul_f32 v26, v133, v133
    v_fma_f32 v26, v26, s59, 1.0
    v_mul_f32 v26, v26, v133
    v_mul_f32 v26, 0x40135761, v26
    v_exp_f32 v26, v26
    s_nop 0
    v_add_f32 v26, 1.0, v26
    v_rcp_f32 v26, v26
    s_nop 0
    v_fma_f32 v26, v26, -2.0, 2.0
    v_mul_f32 v27, 0.5, v133
    v_mul_f32 v133, v27, v26
    v_cvt_pk_bf16_f32 v24, v134, v135
    v_lshlrev_b32 v134, 16, v24
    v_and_b32 v135, 0xffff0000, v24
    v_add_f32 v134, v134, v38
    v_add_f32 v135, v135, v39
    v_cvt_pk_bf16_f32 v24, v134, v135
    v_lshlrev_b32 v134, 16, v24
    v_and_b32 v135, 0xffff0000, v24
    v_mul_f32 v26, v134, v134
    v_fma_f32 v26, v26, s59, 1.0
    v_mul_f32 v26, v26, v134
    v_mul_f32 v26, 0x40135761, v26
    v_exp_f32 v26, v26
    s_nop 0
    v_add_f32 v26, 1.0, v26
    v_rcp_f32 v26, v26
    s_nop 0
    v_fma_f32 v26, v26, -2.0, 2.0
    v_mul_f32 v27, 0.5, v134
    v_mul_f32 v134, v27, v26
    v_mul_f32 v26, v135, v135
    v_fma_f32 v26, v26, s59, 1.0
    v_mul_f32 v26, v26, v135
    v_mul_f32 v26, 0x40135761, v26
    v_exp_f32 v26, v26
    s_nop 0
    v_add_f32 v26, 1.0, v26
    v_rcp_f32 v26, v26
    s_nop 0
    v_fma_f32 v26, v26, -2.0, 2.0
    v_mul_f32 v27, 0.5, v135
    v_mul_f32 v135, v27, v26
    v_cvt_pk_bf16_f32 v24, v132, v133
    v_cvt_pk_bf16_f32 v25, v134, v135
    v_add_u32 v23, 16, v22
    buffer_store_dwordx2 v[24:25], v23, s[16:19], 0 offen
    v_cvt_pk_bf16_f32 v24, v136, v137
    v_lshlrev_b32 v136, 16, v24
    v_and_b32 v137, 0xffff0000, v24
    v_add_f32 v136, v136, v40
    v_add_f32 v137, v137, v41
    v_cvt_pk_bf16_f32 v24, v136, v137
    v_lshlrev_b32 v136, 16, v24
    v_and_b32 v137, 0xffff0000, v24
    v_mul_f32 v26, v136, v136
    v_fma_f32 v26, v26, s59, 1.0
    v_mul_f32 v26, v26, v136
    v_mul_f32 v26, 0x40135761, v26
    v_exp_f32 v26, v26
    s_nop 0
    v_add_f32 v26, 1.0, v26
    v_rcp_f32 v26, v26
    s_nop 0
    v_fma_f32 v26, v26, -2.0, 2.0
    v_mul_f32 v27, 0.5, v136
    v_mul_f32 v136, v27, v26
    v_mul_f32 v26, v137, v137
    v_fma_f32 v26, v26, s59, 1.0
    v_mul_f32 v26, v26, v137
    v_mul_f32 v26, 0x40135761, v26
    v_exp_f32 v26, v26
    s_nop 0
    v_add_f32 v26, 1.0, v26
    v_rcp_f32 v26, v26
    s_nop 0
    v_fma_f32 v26, v26, -2.0, 2.0
    v_mul_f32 v27, 0.5, v137
    v_mul_f32 v137, v27, v26
    v_cvt_pk_bf16_f32 v24, v138, v139
    v_lshlrev_b32 v138, 16, v24
    v_and_b32 v139, 0xffff0000, v24
    v_add_f32 v138, v138, v42
    v_add_f32 v139, v139, v43
    v_cvt_pk_bf16_f32 v24, v138, v139
    v_lshlrev_b32 v138, 16, v24
    v_and_b32 v139, 0xffff0000, v24
    v_mul_f32 v26, v138, v138
    v_fma_f32 v26, v26, s59, 1.0
    v_mul_f32 v26, v26, v138
    v_mul_f32 v26, 0x40135761, v26
    v_exp_f32 v26, v26
    s_nop 0
    v_add_f32 v26, 1.0, v26
    v_rcp_f32 v26, v26
    s_nop 0
    v_fma_f32 v26, v26, -2.0, 2.0
    v_mul_f32 v27, 0.5, v138
    v_mul_f32 v138, v27, v26
    v_mul_f32 v26, v139, v139
    v_fma_f32 v26, v26, s59, 1.0
    v_mul_f32 v26, v26, v139
    v_mul_f32 v26, 0x40135761, v26
    v_exp_f32 v26, v26
    s_nop 0
    v_add_f32 v26, 1.0, v26
    v_rcp_f32 v26, v26
    s_nop 0
    v_fma_f32 v26, v26, -2.0, 2.0
    v_mul_f32 v27, 0.5, v139
    v_mul_f32 v139, v27, v26
    v_cvt_pk_bf16_f32 v24, v136, v137
    v_cvt_pk_bf16_f32 v25, v138, v139
    v_add_u32 v23, 32, v22
    buffer_store_dwordx2 v[24:25], v23, s[16:19], 0 offen
    v_cvt_pk_bf16_f32 v24, v140, v141
    v_lshlrev_b32 v140, 16, v24
    v_and_b32 v141, 0xffff0000, v24
    v_add_f32 v140, v140, v44
    v_add_f32 v141, v141, v45
    v_cvt_pk_bf16_f32 v24, v140, v141
    v_lshlrev_b32 v140, 16, v24
    v_and_b32 v141, 0xffff0000, v24
    v_mul_f32 v26, v140, v140
    v_fma_f32 v26, v26, s59, 1.0
    v_mul_f32 v26, v26, v140
    v_mul_f32 v26, 0x40135761, v26
    v_exp_f32 v26, v26
    s_nop 0
    v_add_f32 v26, 1.0, v26
    v_rcp_f32 v26, v26
    s_nop 0
    v_fma_f32 v26, v26, -2.0, 2.0
    v_mul_f32 v27, 0.5, v140
    v_mul_f32 v140, v27, v26
    v_mul_f32 v26, v141, v141
    v_fma_f32 v26, v26, s59, 1.0
    v_mul_f32 v26, v26, v141
    v_mul_f32 v26, 0x40135761, v26
    v_exp_f32 v26, v26
    s_nop 0
    v_add_f32 v26, 1.0, v26
    v_rcp_f32 v26, v26
    s_nop 0
    v_fma_f32 v26, v26, -2.0, 2.0
    v_mul_f32 v27, 0.5, v141
    v_mul_f32 v141, v27, v26
    v_cvt_pk_bf16_f32 v24, v142, v143
    v_lshlrev_b32 v142, 16, v24
    v_and_b32 v143, 0xffff0000, v24
    v_add_f32 v142, v142, v46
    v_add_f32 v143, v143, v47
    v_cvt_pk_bf16_f32 v24, v142, v143
    v_lshlrev_b32 v142, 16, v24
    v_and_b32 v143, 0xffff0000, v24
    v_mul_f32 v26, v142, v142
    v_fma_f32 v26, v26, s59, 1.0
    v_mul_f32 v26, v26, v142
    v_mul_f32 v26, 0x40135761, v26
    v_exp_f32 v26, v26
    s_nop 0
    v_add_f32 v26, 1.0, v26
    v_rcp_f32 v26, v26
    s_nop 0
    v_fma_f32 v26, v26, -2.0, 2.0
    v_mul_f32 v27, 0.5, v142
    v_mul_f32 v142, v27, v26
    v_mul_f32 v26, v143, v143
    v_fma_f32 v26, v26, s59, 1.0
    v_mul_f32 v26, v26, v143
    v_mul_f32 v26, 0x40135761, v26
    v_exp_f32 v26, v26
    s_nop 0
    v_add_f32 v26, 1.0, v26
    v_rcp_f32 v26, v26
    s_nop 0
    v_fma_f32 v26, v26, -2.0, 2.0
    v_mul_f32 v27, 0.5, v143
    v_mul_f32 v143, v27, v26
    v_cvt_pk_bf16_f32 v24, v140, v141
    v_cvt_pk_bf16_f32 v25, v142, v143
    v_add_u32 v23, 48, v22
    buffer_store_dwordx2 v[24:25], v23, s[16:19], 0 offen
    v_cvt_pk_bf16_f32 v24, v144, v145
    v_lshlrev_b32 v144, 16, v24
    v_and_b32 v145, 0xffff0000, v24
    v_add_f32 v144, v144, v32
    v_add_f32 v145, v145, v33
    v_cvt_pk_bf16_f32 v24, v144, v145
    v_lshlrev_b32 v144, 16, v24
    v_and_b32 v145, 0xffff0000, v24
    v_mul_f32 v26, v144, v144
    v_fma_f32 v26, v26, s59, 1.0
    v_mul_f32 v26, v26, v144
    v_mul_f32 v26, 0x40135761, v26
    v_exp_f32 v26, v26
    s_nop 0
    v_add_f32 v26, 1.0, v26
    v_rcp_f32 v26, v26
    s_nop 0
    v_fma_f32 v26, v26, -2.0, 2.0
    v_mul_f32 v27, 0.5, v144
    v_mul_f32 v144, v27, v26
    v_mul_f32 v26, v145, v145
    v_fma_f32 v26, v26, s59, 1.0
    v_mul_f32 v26, v26, v145
    v_mul_f32 v26, 0x40135761, v26
    v_exp_f32 v26, v26
    s_nop 0
    v_add_f32 v26, 1.0, v26
    v_rcp_f32 v26, v26
    s_nop 0
    v_fma_f32 v26, v26, -2.0, 2.0
    v_mul_f32 v27, 0.5, v145
    v_mul_f32 v145, v27, v26
    v_cvt_pk_bf16_f32 v24, v146, v147
    v_lshlrev_b32 v146, 16, v24
    v_and_b32 v147, 0xffff0000, v24
    v_add_f32 v146, v146, v34
    v_add_f32 v147, v147, v35
    v_cvt_pk_bf16_f32 v24, v146, v147
    v_lshlrev_b32 v146, 16, v24
    v_and_b32 v147, 0xffff0000, v24
    v_mul_f32 v26, v146, v146
    v_fma_f32 v26, v26, s59, 1.0
    v_mul_f32 v26, v26, v146
    v_mul_f32 v26, 0x40135761, v26
    v_exp_f32 v26, v26
    s_nop 0
    v_add_f32 v26, 1.0, v26
    v_rcp_f32 v26, v26
    s_nop 0
    v_fma_f32 v26, v26, -2.0, 2.0
    v_mul_f32 v27, 0.5, v146
    v_mul_f32 v146, v27, v26
    v_mul_f32 v26, v147, v147
    v_fma_f32 v26, v26, s59, 1.0
    v_mul_f32 v26, v26, v147
    v_mul_f32 v26, 0x40135761, v26
    v_exp_f32 v26, v26
    s_nop 0
    v_add_f32 v26, 1.0, v26
    v_rcp_f32 v26, v26
    s_nop 0
    v_fma_f32 v26, v26, -2.0, 2.0
    v_mul_f32 v27, 0.5, v147
    v_mul_f32 v147, v27, v26
    v_cvt_pk_bf16_f32 v24, v144, v145
    v_cvt_pk_bf16_f32 v25, v146, v147
    v_add_u32 v23, 229376, v22
    buffer_store_dwordx2 v[24:25], v23, s[16:19], 0 offen
    v_cvt_pk_bf16_f32 v24, v148, v149
    v_lshlrev_b32 v148, 16, v24
    v_and_b32 v149, 0xffff0000, v24
    v_add_f32 v148, v148, v36
    v_add_f32 v149, v149, v37
    v_cvt_pk_bf16_f32 v24, v148, v149
    v_lshlrev_b32 v148, 16, v24
    v_and_b32 v149, 0xffff0000, v24
    v_mul_f32 v26, v148, v148
    v_fma_f32 v26, v26, s59, 1.0
    v_mul_f32 v26, v26, v148
    v_mul_f32 v26, 0x40135761, v26
    v_exp_f32 v26, v26
    s_nop 0
    v_add_f32 v26, 1.0, v26
    v_rcp_f32 v26, v26
    s_nop 0
    v_fma_f32 v26, v26, -2.0, 2.0
    v_mul_f32 v27, 0.5, v148
    v_mul_f32 v148, v27, v26
    v_mul_f32 v26, v149, v149
    v_fma_f32 v26, v26, s59, 1.0
    v_mul_f32 v26, v26, v149
    v_mul_f32 v26, 0x40135761, v26
    v_exp_f32 v26, v26
    s_nop 0
    v_add_f32 v26, 1.0, v26
    v_rcp_f32 v26, v26
    s_nop 0
    v_fma_f32 v26, v26, -2.0, 2.0
    v_mul_f32 v27, 0.5, v149
    v_mul_f32 v149, v27, v26
    v_cvt_pk_bf16_f32 v24, v150, v151
    v_lshlrev_b32 v150, 16, v24
    v_and_b32 v151, 0xffff0000, v24
    v_add_f32 v150, v150, v38
    v_add_f32 v151, v151, v39
    v_cvt_pk_bf16_f32 v24, v150, v151
    v_lshlrev_b32 v150, 16, v24
    v_and_b32 v151, 0xffff0000, v24
    v_mul_f32 v26, v150, v150
    v_fma_f32 v26, v26, s59, 1.0
    v_mul_f32 v26, v26, v150
    v_mul_f32 v26, 0x40135761, v26
    v_exp_f32 v26, v26
    s_nop 0
    v_add_f32 v26, 1.0, v26
    v_rcp_f32 v26, v26
    s_nop 0
    v_fma_f32 v26, v26, -2.0, 2.0
    v_mul_f32 v27, 0.5, v150
    v_mul_f32 v150, v27, v26
    v_mul_f32 v26, v151, v151
    v_fma_f32 v26, v26, s59, 1.0
    v_mul_f32 v26, v26, v151
    v_mul_f32 v26, 0x40135761, v26
    v_exp_f32 v26, v26
    s_nop 0
    v_add_f32 v26, 1.0, v26
    v_rcp_f32 v26, v26
    s_nop 0
    v_fma_f32 v26, v26, -2.0, 2.0
    v_mul_f32 v27, 0.5, v151
    v_mul_f32 v151, v27, v26
    v_cvt_pk_bf16_f32 v24, v148, v149
    v_cvt_pk_bf16_f32 v25, v150, v151
    v_add_u32 v23, 229392, v22
    buffer_store_dwordx2 v[24:25], v23, s[16:19], 0 offen
    v_cvt_pk_bf16_f32 v24, v152, v153
    v_lshlrev_b32 v152, 16, v24
    v_and_b32 v153, 0xffff0000, v24
    v_add_f32 v152, v152, v40
    v_add_f32 v153, v153, v41
    v_cvt_pk_bf16_f32 v24, v152, v153
    v_lshlrev_b32 v152, 16, v24
    v_and_b32 v153, 0xffff0000, v24
    v_mul_f32 v26, v152, v152
    v_fma_f32 v26, v26, s59, 1.0
    v_mul_f32 v26, v26, v152
    v_mul_f32 v26, 0x40135761, v26
    v_exp_f32 v26, v26
    s_nop 0
    v_add_f32 v26, 1.0, v26
    v_rcp_f32 v26, v26
    s_nop 0
    v_fma_f32 v26, v26, -2.0, 2.0
    v_mul_f32 v27, 0.5, v152
    v_mul_f32 v152, v27, v26
    v_mul_f32 v26, v153, v153
    v_fma_f32 v26, v26, s59, 1.0
    v_mul_f32 v26, v26, v153
    v_mul_f32 v26, 0x40135761, v26
    v_exp_f32 v26, v26
    s_nop 0
    v_add_f32 v26, 1.0, v26
    v_rcp_f32 v26, v26
    s_nop 0
    v_fma_f32 v26, v26, -2.0, 2.0
    v_mul_f32 v27, 0.5, v153
    v_mul_f32 v153, v27, v26
    v_cvt_pk_bf16_f32 v24, v154, v155
    v_lshlrev_b32 v154, 16, v24
    v_and_b32 v155, 0xffff0000, v24
    v_add_f32 v154, v154, v42
    v_add_f32 v155, v155, v43
    v_cvt_pk_bf16_f32 v24, v154, v155
    v_lshlrev_b32 v154, 16, v24
    v_and_b32 v155, 0xffff0000, v24
    v_mul_f32 v26, v154, v154
    v_fma_f32 v26, v26, s59, 1.0
    v_mul_f32 v26, v26, v154
    v_mul_f32 v26, 0x40135761, v26
    v_exp_f32 v26, v26
    s_nop 0
    v_add_f32 v26, 1.0, v26
    v_rcp_f32 v26, v26
    s_nop 0
    v_fma_f32 v26, v26, -2.0, 2.0
    v_mul_f32 v27, 0.5, v154
    v_mul_f32 v154, v27, v26
    v_mul_f32 v26, v155, v155
    v_fma_f32 v26, v26, s59, 1.0
    v_mul_f32 v26, v26, v155
    v_mul_f32 v26, 0x40135761, v26
    v_exp_f32 v26, v26
    s_nop 0
    v_add_f32 v26, 1.0, v26
    v_rcp_f32 v26, v26
    s_nop 0
    v_fma_f32 v26, v26, -2.0, 2.0
    v_mul_f32 v27, 0.5, v155
    v_mul_f32 v155, v27, v26
    v_cvt_pk_bf16_f32 v24, v152, v153
    v_cvt_pk_bf16_f32 v25, v154, v155
    v_add_u32 v23, 229408, v22
    buffer_store_dwordx2 v[24:25], v23, s[16:19], 0 offen
    v_cvt_pk_bf16_f32 v24, v156, v157
    v_lshlrev_b32 v156, 16, v24
    v_and_b32 v157, 0xffff0000, v24
    v_add_f32 v156, v156, v44
    v_add_f32 v157, v157, v45
    v_cvt_pk_bf16_f32 v24, v156, v157
    v_lshlrev_b32 v156, 16, v24
    v_and_b32 v157, 0xffff0000, v24
    v_mul_f32 v26, v156, v156
    v_fma_f32 v26, v26, s59, 1.0
    v_mul_f32 v26, v26, v156
    v_mul_f32 v26, 0x40135761, v26
    v_exp_f32 v26, v26
    s_nop 0
    v_add_f32 v26, 1.0, v26
    v_rcp_f32 v26, v26
    s_nop 0
    v_fma_f32 v26, v26, -2.0, 2.0
    v_mul_f32 v27, 0.5, v156
    v_mul_f32 v156, v27, v26
    v_mul_f32 v26, v157, v157
    v_fma_f32 v26, v26, s59, 1.0
    v_mul_f32 v26, v26, v157
    v_mul_f32 v26, 0x40135761, v26
    v_exp_f32 v26, v26
    s_nop 0
    v_add_f32 v26, 1.0, v26
    v_rcp_f32 v26, v26
    s_nop 0
    v_fma_f32 v26, v26, -2.0, 2.0
    v_mul_f32 v27, 0.5, v157
    v_mul_f32 v157, v27, v26
    v_cvt_pk_bf16_f32 v24, v158, v159
    v_lshlrev_b32 v158, 16, v24
    v_and_b32 v159, 0xffff0000, v24
    v_add_f32 v158, v158, v46
    v_add_f32 v159, v159, v47
    v_cvt_pk_bf16_f32 v24, v158, v159
    v_lshlrev_b32 v158, 16, v24
    v_and_b32 v159, 0xffff0000, v24
    v_mul_f32 v26, v158, v158
    v_fma_f32 v26, v26, s59, 1.0
    v_mul_f32 v26, v26, v158
    v_mul_f32 v26, 0x40135761, v26
    v_exp_f32 v26, v26
    s_nop 0
    v_add_f32 v26, 1.0, v26
    v_rcp_f32 v26, v26
    s_nop 0
    v_fma_f32 v26, v26, -2.0, 2.0
    v_mul_f32 v27, 0.5, v158
    v_mul_f32 v158, v27, v26
    v_mul_f32 v26, v159, v159
    v_fma_f32 v26, v26, s59, 1.0
    v_mul_f32 v26, v26, v159
    v_mul_f32 v26, 0x40135761, v26
    v_exp_f32 v26, v26
    s_nop 0
    v_add_f32 v26, 1.0, v26
    v_rcp_f32 v26, v26
    s_nop 0
    v_fma_f32 v26, v26, -2.0, 2.0
    v_mul_f32 v27, 0.5, v159
    v_mul_f32 v159, v27, v26
    v_cvt_pk_bf16_f32 v24, v156, v157
    v_cvt_pk_bf16_f32 v25, v158, v159
    v_add_u32 v23, 229424, v22
    buffer_store_dwordx2 v[24:25], v23, s[16:19], 0 offen
    v_cvt_pk_bf16_f32 v24, v160, v161
    v_lshlrev_b32 v160, 16, v24
    v_and_b32 v161, 0xffff0000, v24
    v_add_f32 v160, v160, v48
    v_add_f32 v161, v161, v49
    v_cvt_pk_bf16_f32 v24, v160, v161
    v_lshlrev_b32 v160, 16, v24
    v_and_b32 v161, 0xffff0000, v24
    v_mul_f32 v26, v160, v160
    v_fma_f32 v26, v26, s59, 1.0
    v_mul_f32 v26, v26, v160
    v_mul_f32 v26, 0x40135761, v26
    v_exp_f32 v26, v26
    s_nop 0
    v_add_f32 v26, 1.0, v26
    v_rcp_f32 v26, v26
    s_nop 0
    v_fma_f32 v26, v26, -2.0, 2.0
    v_mul_f32 v27, 0.5, v160
    v_mul_f32 v160, v27, v26
    v_mul_f32 v26, v161, v161
    v_fma_f32 v26, v26, s59, 1.0
    v_mul_f32 v26, v26, v161
    v_mul_f32 v26, 0x40135761, v26
    v_exp_f32 v26, v26
    s_nop 0
    v_add_f32 v26, 1.0, v26
    v_rcp_f32 v26, v26
    s_nop 0
    v_fma_f32 v26, v26, -2.0, 2.0
    v_mul_f32 v27, 0.5, v161
    v_mul_f32 v161, v27, v26
    v_cvt_pk_bf16_f32 v24, v162, v163
    v_lshlrev_b32 v162, 16, v24
    v_and_b32 v163, 0xffff0000, v24
    v_add_f32 v162, v162, v50
    v_add_f32 v163, v163, v51
    v_cvt_pk_bf16_f32 v24, v162, v163
    v_lshlrev_b32 v162, 16, v24
    v_and_b32 v163, 0xffff0000, v24
    v_mul_f32 v26, v162, v162
    v_fma_f32 v26, v26, s59, 1.0
    v_mul_f32 v26, v26, v162
    v_mul_f32 v26, 0x40135761, v26
    v_exp_f32 v26, v26
    s_nop 0
    v_add_f32 v26, 1.0, v26
    v_rcp_f32 v26, v26
    s_nop 0
    v_fma_f32 v26, v26, -2.0, 2.0
    v_mul_f32 v27, 0.5, v162
    v_mul_f32 v162, v27, v26
    v_mul_f32 v26, v163, v163
    v_fma_f32 v26, v26, s59, 1.0
    v_mul_f32 v26, v26, v163
    v_mul_f32 v26, 0x40135761, v26
    v_exp_f32 v26, v26
    s_nop 0
    v_add_f32 v26, 1.0, v26
    v_rcp_f32 v26, v26
    s_nop 0
    v_fma_f32 v26, v26, -2.0, 2.0
    v_mul_f32 v27, 0.5, v163
    v_mul_f32 v163, v27, v26
    v_cvt_pk_bf16_f32 v24, v160, v161
    v_cvt_pk_bf16_f32 v25, v162, v163
    v_add_u32 v23, 64, v22
    buffer_store_dwordx2 v[24:25], v23, s[16:19], 0 offen
    v_cvt_pk_bf16_f32 v24, v164, v165
    v_lshlrev_b32 v164, 16, v24
    v_and_b32 v165, 0xffff0000, v24
    v_add_f32 v164, v164, v52
    v_add_f32 v165, v165, v53
    v_cvt_pk_bf16_f32 v24, v164, v165
    v_lshlrev_b32 v164, 16, v24
    v_and_b32 v165, 0xffff0000, v24
    v_mul_f32 v26, v164, v164
    v_fma_f32 v26, v26, s59, 1.0
    v_mul_f32 v26, v26, v164
    v_mul_f32 v26, 0x40135761, v26
    v_exp_f32 v26, v26
    s_nop 0
    v_add_f32 v26, 1.0, v26
    v_rcp_f32 v26, v26
    s_nop 0
    v_fma_f32 v26, v26, -2.0, 2.0
    v_mul_f32 v27, 0.5, v164
    v_mul_f32 v164, v27, v26
    v_mul_f32 v26, v165, v165
    v_fma_f32 v26, v26, s59, 1.0
    v_mul_f32 v26, v26, v165
    v_mul_f32 v26, 0x40135761, v26
    v_exp_f32 v26, v26
    s_nop 0
    v_add_f32 v26, 1.0, v26
    v_rcp_f32 v26, v26
    s_nop 0
    v_fma_f32 v26, v26, -2.0, 2.0
    v_mul_f32 v27, 0.5, v165
    v_mul_f32 v165, v27, v26
    v_cvt_pk_bf16_f32 v24, v166, v167
    v_lshlrev_b32 v166, 16, v24
    v_and_b32 v167, 0xffff0000, v24
    v_add_f32 v166, v166, v54
    v_add_f32 v167, v167, v55
    v_cvt_pk_bf16_f32 v24, v166, v167
    v_lshlrev_b32 v166, 16, v24
    v_and_b32 v167, 0xffff0000, v24
    v_mul_f32 v26, v166, v166
    v_fma_f32 v26, v26, s59, 1.0
    v_mul_f32 v26, v26, v166
    v_mul_f32 v26, 0x40135761, v26
    v_exp_f32 v26, v26
    s_nop 0
    v_add_f32 v26, 1.0, v26
    v_rcp_f32 v26, v26
    s_nop 0
    v_fma_f32 v26, v26, -2.0, 2.0
    v_mul_f32 v27, 0.5, v166
    v_mul_f32 v166, v27, v26
    v_mul_f32 v26, v167, v167
    v_fma_f32 v26, v26, s59, 1.0
    v_mul_f32 v26, v26, v167
    v_mul_f32 v26, 0x40135761, v26
    v_exp_f32 v26, v26
    s_nop 0
    v_add_f32 v26, 1.0, v26
    v_rcp_f32 v26, v26
    s_nop 0
    v_fma_f32 v26, v26, -2.0, 2.0
    v_mul_f32 v27, 0.5, v167
    v_mul_f32 v167, v27, v26
    v_cvt_pk_bf16_f32 v24, v164, v165
    v_cvt_pk_bf16_f32 v25, v166, v167
    v_add_u32 v23, 80, v22
    buffer_store_dwordx2 v[24:25], v23, s[16:19], 0 offen
    v_cvt_pk_bf16_f32 v24, v168, v169
    v_lshlrev_b32 v168, 16, v24
    v_and_b32 v169, 0xffff0000, v24
    v_add_f32 v168, v168, v56
    v_add_f32 v169, v169, v57
    v_cvt_pk_bf16_f32 v24, v168, v169
    v_lshlrev_b32 v168, 16, v24
    v_and_b32 v169, 0xffff0000, v24
    v_mul_f32 v26, v168, v168
    v_fma_f32 v26, v26, s59, 1.0
    v_mul_f32 v26, v26, v168
    v_mul_f32 v26, 0x40135761, v26
    v_exp_f32 v26, v26
    s_nop 0
    v_add_f32 v26, 1.0, v26
    v_rcp_f32 v26, v26
    s_nop 0
    v_fma_f32 v26, v26, -2.0, 2.0
    v_mul_f32 v27, 0.5, v168
    v_mul_f32 v168, v27, v26
    v_mul_f32 v26, v169, v169
    v_fma_f32 v26, v26, s59, 1.0
    v_mul_f32 v26, v26, v169
    v_mul_f32 v26, 0x40135761, v26
    v_exp_f32 v26, v26
    s_nop 0
    v_add_f32 v26, 1.0, v26
    v_rcp_f32 v26, v26
    s_nop 0
    v_fma_f32 v26, v26, -2.0, 2.0
    v_mul_f32 v27, 0.5, v169
    v_mul_f32 v169, v27, v26
    v_cvt_pk_bf16_f32 v24, v170, v171
    v_lshlrev_b32 v170, 16, v24
    v_and_b32 v171, 0xffff0000, v24
    v_add_f32 v170, v170, v58
    v_add_f32 v171, v171, v59
    v_cvt_pk_bf16_f32 v24, v170, v171
    v_lshlrev_b32 v170, 16, v24
    v_and_b32 v171, 0xffff0000, v24
    v_mul_f32 v26, v170, v170
    v_fma_f32 v26, v26, s59, 1.0
    v_mul_f32 v26, v26, v170
    v_mul_f32 v26, 0x40135761, v26
    v_exp_f32 v26, v26
    s_nop 0
    v_add_f32 v26, 1.0, v26
    v_rcp_f32 v26, v26
    s_nop 0
    v_fma_f32 v26, v26, -2.0, 2.0
    v_mul_f32 v27, 0.5, v170
    v_mul_f32 v170, v27, v26
    v_mul_f32 v26, v171, v171
    v_fma_f32 v26, v26, s59, 1.0
    v_mul_f32 v26, v26, v171
    v_mul_f32 v26, 0x40135761, v26
    v_exp_f32 v26, v26
    s_nop 0
    v_add_f32 v26, 1.0, v26
    v_rcp_f32 v26, v26
    s_nop 0
    v_fma_f32 v26, v26, -2.0, 2.0
    v_mul_f32 v27, 0.5, v171
    v_mul_f32 v171, v27, v26
    v_cvt_pk_bf16_f32 v24, v168, v169
    v_cvt_pk_bf16_f32 v25, v170, v171
    v_add_u32 v23, 96, v22
    buffer_store_dwordx2 v[24:25], v23, s[16:19], 0 offen
    v_cvt_pk_bf16_f32 v24, v172, v173
    v_lshlrev_b32 v172, 16, v24
    v_and_b32 v173, 0xffff0000, v24
    v_add_f32 v172, v172, v60
    v_add_f32 v173, v173, v61
    v_cvt_pk_bf16_f32 v24, v172, v173
    v_lshlrev_b32 v172, 16, v24
    v_and_b32 v173, 0xffff0000, v24
    v_mul_f32 v26, v172, v172
    v_fma_f32 v26, v26, s59, 1.0
    v_mul_f32 v26, v26, v172
    v_mul_f32 v26, 0x40135761, v26
    v_exp_f32 v26, v26
    s_nop 0
    v_add_f32 v26, 1.0, v26
    v_rcp_f32 v26, v26
    s_nop 0
    v_fma_f32 v26, v26, -2.0, 2.0
    v_mul_f32 v27, 0.5, v172
    v_mul_f32 v172, v27, v26
    v_mul_f32 v26, v173, v173
    v_fma_f32 v26, v26, s59, 1.0
    v_mul_f32 v26, v26, v173
    v_mul_f32 v26, 0x40135761, v26
    v_exp_f32 v26, v26
    s_nop 0
    v_add_f32 v26, 1.0, v26
    v_rcp_f32 v26, v26
    s_nop 0
    v_fma_f32 v26, v26, -2.0, 2.0
    v_mul_f32 v27, 0.5, v173
    v_mul_f32 v173, v27, v26
    v_cvt_pk_bf16_f32 v24, v174, v175
    v_lshlrev_b32 v174, 16, v24
    v_and_b32 v175, 0xffff0000, v24
    v_add_f32 v174, v174, v62
    v_add_f32 v175, v175, v63
    v_cvt_pk_bf16_f32 v24, v174, v175
    v_lshlrev_b32 v174, 16, v24
    v_and_b32 v175, 0xffff0000, v24
    v_mul_f32 v26, v174, v174
    v_fma_f32 v26, v26, s59, 1.0
    v_mul_f32 v26, v26, v174
    v_mul_f32 v26, 0x40135761, v26
    v_exp_f32 v26, v26
    s_nop 0
    v_add_f32 v26, 1.0, v26
    v_rcp_f32 v26, v26
    s_nop 0
    v_fma_f32 v26, v26, -2.0, 2.0
    v_mul_f32 v27, 0.5, v174
    v_mul_f32 v174, v27, v26
    v_mul_f32 v26, v175, v175
    v_fma_f32 v26, v26, s59, 1.0
    v_mul_f32 v26, v26, v175
    v_mul_f32 v26, 0x40135761, v26
    v_exp_f32 v26, v26
    s_nop 0
    v_add_f32 v26, 1.0, v26
    v_rcp_f32 v26, v26
    s_nop 0
    v_fma_f32 v26, v26, -2.0, 2.0
    v_mul_f32 v27, 0.5, v175
    v_mul_f32 v175, v27, v26
    v_cvt_pk_bf16_f32 v24, v172, v173
    v_cvt_pk_bf16_f32 v25, v174, v175
    v_add_u32 v23, 112, v22
    buffer_store_dwordx2 v[24:25], v23, s[16:19], 0 offen
    v_cvt_pk_bf16_f32 v24, v176, v177
    v_lshlrev_b32 v176, 16, v24
    v_and_b32 v177, 0xffff0000, v24
    v_add_f32 v176, v176, v48
    v_add_f32 v177, v177, v49
    v_cvt_pk_bf16_f32 v24, v176, v177
    v_lshlrev_b32 v176, 16, v24
    v_and_b32 v177, 0xffff0000, v24
    v_mul_f32 v26, v176, v176
    v_fma_f32 v26, v26, s59, 1.0
    v_mul_f32 v26, v26, v176
    v_mul_f32 v26, 0x40135761, v26
    v_exp_f32 v26, v26
    s_nop 0
    v_add_f32 v26, 1.0, v26
    v_rcp_f32 v26, v26
    s_nop 0
    v_fma_f32 v26, v26, -2.0, 2.0
    v_mul_f32 v27, 0.5, v176
    v_mul_f32 v176, v27, v26
    v_mul_f32 v26, v177, v177
    v_fma_f32 v26, v26, s59, 1.0
    v_mul_f32 v26, v26, v177
    v_mul_f32 v26, 0x40135761, v26
    v_exp_f32 v26, v26
    s_nop 0
    v_add_f32 v26, 1.0, v26
    v_rcp_f32 v26, v26
    s_nop 0
    v_fma_f32 v26, v26, -2.0, 2.0
    v_mul_f32 v27, 0.5, v177
    v_mul_f32 v177, v27, v26
    v_cvt_pk_bf16_f32 v24, v178, v179
    v_lshlrev_b32 v178, 16, v24
    v_and_b32 v179, 0xffff0000, v24
    v_add_f32 v178, v178, v50
    v_add_f32 v179, v179, v51
    v_cvt_pk_bf16_f32 v24, v178, v179
    v_lshlrev_b32 v178, 16, v24
    v_and_b32 v179, 0xffff0000, v24
    v_mul_f32 v26, v178, v178
    v_fma_f32 v26, v26, s59, 1.0
    v_mul_f32 v26, v26, v178
    v_mul_f32 v26, 0x40135761, v26
    v_exp_f32 v26, v26
    s_nop 0
    v_add_f32 v26, 1.0, v26
    v_rcp_f32 v26, v26
    s_nop 0
    v_fma_f32 v26, v26, -2.0, 2.0
    v_mul_f32 v27, 0.5, v178
    v_mul_f32 v178, v27, v26
    v_mul_f32 v26, v179, v179
    v_fma_f32 v26, v26, s59, 1.0
    v_mul_f32 v26, v26, v179
    v_mul_f32 v26, 0x40135761, v26
    v_exp_f32 v26, v26
    s_nop 0
    v_add_f32 v26, 1.0, v26
    v_rcp_f32 v26, v26
    s_nop 0
    v_fma_f32 v26, v26, -2.0, 2.0
    v_mul_f32 v27, 0.5, v179
    v_mul_f32 v179, v27, v26
    v_cvt_pk_bf16_f32 v24, v176, v177
    v_cvt_pk_bf16_f32 v25, v178, v179
    v_add_u32 v23, 229440, v22
    buffer_store_dwordx2 v[24:25], v23, s[16:19], 0 offen
    v_cvt_pk_bf16_f32 v24, v180, v181
    v_lshlrev_b32 v180, 16, v24
    v_and_b32 v181, 0xffff0000, v24
    v_add_f32 v180, v180, v52
    v_add_f32 v181, v181, v53
    v_cvt_pk_bf16_f32 v24, v180, v181
    v_lshlrev_b32 v180, 16, v24
    v_and_b32 v181, 0xffff0000, v24
    v_mul_f32 v26, v180, v180
    v_fma_f32 v26, v26, s59, 1.0
    v_mul_f32 v26, v26, v180
    v_mul_f32 v26, 0x40135761, v26
    v_exp_f32 v26, v26
    s_nop 0
    v_add_f32 v26, 1.0, v26
    v_rcp_f32 v26, v26
    s_nop 0
    v_fma_f32 v26, v26, -2.0, 2.0
    v_mul_f32 v27, 0.5, v180
    v_mul_f32 v180, v27, v26
    v_mul_f32 v26, v181, v181
    v_fma_f32 v26, v26, s59, 1.0
    v_mul_f32 v26, v26, v181
    v_mul_f32 v26, 0x40135761, v26
    v_exp_f32 v26, v26
    s_nop 0
    v_add_f32 v26, 1.0, v26
    v_rcp_f32 v26, v26
    s_nop 0
    v_fma_f32 v26, v26, -2.0, 2.0
    v_mul_f32 v27, 0.5, v181
    v_mul_f32 v181, v27, v26
    v_cvt_pk_bf16_f32 v24, v182, v183
    v_lshlrev_b32 v182, 16, v24
    v_and_b32 v183, 0xffff0000, v24
    v_add_f32 v182, v182, v54
    v_add_f32 v183, v183, v55
    v_cvt_pk_bf16_f32 v24, v182, v183
    v_lshlrev_b32 v182, 16, v24
    v_and_b32 v183, 0xffff0000, v24
    v_mul_f32 v26, v182, v182
    v_fma_f32 v26, v26, s59, 1.0
    v_mul_f32 v26, v26, v182
    v_mul_f32 v26, 0x40135761, v26
    v_exp_f32 v26, v26
    s_nop 0
    v_add_f32 v26, 1.0, v26
    v_rcp_f32 v26, v26
    s_nop 0
    v_fma_f32 v26, v26, -2.0, 2.0
    v_mul_f32 v27, 0.5, v182
    v_mul_f32 v182, v27, v26
    v_mul_f32 v26, v183, v183
    v_fma_f32 v26, v26, s59, 1.0
    v_mul_f32 v26, v26, v183
    v_mul_f32 v26, 0x40135761, v26
    v_exp_f32 v26, v26
    s_nop 0
    v_add_f32 v26, 1.0, v26
    v_rcp_f32 v26, v26
    s_nop 0
    v_fma_f32 v26, v26, -2.0, 2.0
    v_mul_f32 v27, 0.5, v183
    v_mul_f32 v183, v27, v26
    v_cvt_pk_bf16_f32 v24, v180, v181
    v_cvt_pk_bf16_f32 v25, v182, v183
    v_add_u32 v23, 229456, v22
    buffer_store_dwordx2 v[24:25], v23, s[16:19], 0 offen
    v_cvt_pk_bf16_f32 v24, v184, v185
    v_lshlrev_b32 v184, 16, v24
    v_and_b32 v185, 0xffff0000, v24
    v_add_f32 v184, v184, v56
    v_add_f32 v185, v185, v57
    v_cvt_pk_bf16_f32 v24, v184, v185
    v_lshlrev_b32 v184, 16, v24
    v_and_b32 v185, 0xffff0000, v24
    v_mul_f32 v26, v184, v184
    v_fma_f32 v26, v26, s59, 1.0
    v_mul_f32 v26, v26, v184
    v_mul_f32 v26, 0x40135761, v26
    v_exp_f32 v26, v26
    s_nop 0
    v_add_f32 v26, 1.0, v26
    v_rcp_f32 v26, v26
    s_nop 0
    v_fma_f32 v26, v26, -2.0, 2.0
    v_mul_f32 v27, 0.5, v184
    v_mul_f32 v184, v27, v26
    v_mul_f32 v26, v185, v185
    v_fma_f32 v26, v26, s59, 1.0
    v_mul_f32 v26, v26, v185
    v_mul_f32 v26, 0x40135761, v26
    v_exp_f32 v26, v26
    s_nop 0
    v_add_f32 v26, 1.0, v26
    v_rcp_f32 v26, v26
    s_nop 0
    v_fma_f32 v26, v26, -2.0, 2.0
    v_mul_f32 v27, 0.5, v185
    v_mul_f32 v185, v27, v26
    v_cvt_pk_bf16_f32 v24, v186, v187
    v_lshlrev_b32 v186, 16, v24
    v_and_b32 v187, 0xffff0000, v24
    v_add_f32 v186, v186, v58
    v_add_f32 v187, v187, v59
    v_cvt_pk_bf16_f32 v24, v186, v187
    v_lshlrev_b32 v186, 16, v24
    v_and_b32 v187, 0xffff0000, v24
    v_mul_f32 v26, v186, v186
    v_fma_f32 v26, v26, s59, 1.0
    v_mul_f32 v26, v26, v186
    v_mul_f32 v26, 0x40135761, v26
    v_exp_f32 v26, v26
    s_nop 0
    v_add_f32 v26, 1.0, v26
    v_rcp_f32 v26, v26
    s_nop 0
    v_fma_f32 v26, v26, -2.0, 2.0
    v_mul_f32 v27, 0.5, v186
    v_mul_f32 v186, v27, v26
    v_mul_f32 v26, v187, v187
    v_fma_f32 v26, v26, s59, 1.0
    v_mul_f32 v26, v26, v187
    v_mul_f32 v26, 0x40135761, v26
    v_exp_f32 v26, v26
    s_nop 0
    v_add_f32 v26, 1.0, v26
    v_rcp_f32 v26, v26
    s_nop 0
    v_fma_f32 v26, v26, -2.0, 2.0
    v_mul_f32 v27, 0.5, v187
    v_mul_f32 v187, v27, v26
    v_cvt_pk_bf16_f32 v24, v184, v185
    v_cvt_pk_bf16_f32 v25, v186, v187
    v_add_u32 v23, 229472, v22
    buffer_store_dwordx2 v[24:25], v23, s[16:19], 0 offen
    v_cvt_pk_bf16_f32 v24, v188, v189
    v_lshlrev_b32 v188, 16, v24
    v_and_b32 v189, 0xffff0000, v24
    v_add_f32 v188, v188, v60
    v_add_f32 v189, v189, v61
    v_cvt_pk_bf16_f32 v24, v188, v189
    v_lshlrev_b32 v188, 16, v24
    v_and_b32 v189, 0xffff0000, v24
    v_mul_f32 v26, v188, v188
    v_fma_f32 v26, v26, s59, 1.0
    v_mul_f32 v26, v26, v188
    v_mul_f32 v26, 0x40135761, v26
    v_exp_f32 v26, v26
    s_nop 0
    v_add_f32 v26, 1.0, v26
    v_rcp_f32 v26, v26
    s_nop 0
    v_fma_f32 v26, v26, -2.0, 2.0
    v_mul_f32 v27, 0.5, v188
    v_mul_f32 v188, v27, v26
    v_mul_f32 v26, v189, v189
    v_fma_f32 v26, v26, s59, 1.0
    v_mul_f32 v26, v26, v189
    v_mul_f32 v26, 0x40135761, v26
    v_exp_f32 v26, v26
    s_nop 0
    v_add_f32 v26, 1.0, v26
    v_rcp_f32 v26, v26
    s_nop 0
    v_fma_f32 v26, v26, -2.0, 2.0
    v_mul_f32 v27, 0.5, v189
    v_mul_f32 v189, v27, v26
    v_cvt_pk_bf16_f32 v24, v190, v191
    v_lshlrev_b32 v190, 16, v24
    v_and_b32 v191, 0xffff0000, v24
    v_add_f32 v190, v190, v62
    v_add_f32 v191, v191, v63
    v_cvt_pk_bf16_f32 v24, v190, v191
    v_lshlrev_b32 v190, 16, v24
    v_and_b32 v191, 0xffff0000, v24
    v_mul_f32 v26, v190, v190
    v_fma_f32 v26, v26, s59, 1.0
    v_mul_f32 v26, v26, v190
    v_mul_f32 v26, 0x40135761, v26
    v_exp_f32 v26, v26
    s_nop 0
    v_add_f32 v26, 1.0, v26
    v_rcp_f32 v26, v26
    s_nop 0
    v_fma_f32 v26, v26, -2.0, 2.0
    v_mul_f32 v27, 0.5, v190
    v_mul_f32 v190, v27, v26
    v_mul_f32 v26, v191, v191
    v_fma_f32 v26, v26, s59, 1.0
    v_mul_f32 v26, v26, v191
    v_mul_f32 v26, 0x40135761, v26
    v_exp_f32 v26, v26
    s_nop 0
    v_add_f32 v26, 1.0, v26
    v_rcp_f32 v26, v26
    s_nop 0
    v_fma_f32 v26, v26, -2.0, 2.0
    v_mul_f32 v27, 0.5, v191
    v_mul_f32 v191, v27, v26
    v_cvt_pk_bf16_f32 v24, v188, v189
    v_cvt_pk_bf16_f32 v25, v190, v191
    v_add_u32 v23, 229488, v22
    buffer_store_dwordx2 v[24:25], v23, s[16:19], 0 offen
G1_done:
    s_endpgm
.globl rec_kernel
.p2align 8
.type rec_kernel,@function
rec_kernel:
    s_cmp_ge_u32 s2, 256
    s_cbranch_scc1 R_done
    s_load_dwordx2 s[4:5], s[0:1], 112
    s_load_dwordx2 s[16:17], s[0:1], 16
    s_load_dwordx2 s[20:21], s[0:1], 24
    s_load_dwordx2 s[24:25], s[0:1], 32
    s_load_dwordx2 s[28:29], s[0:1], 40
    s_load_dwordx2 s[32:33], s[0:1], 8
    s_and_b32 s50, s2, 31
    s_lshr_b32 s51, s2, 5
    v_lshrrev_b32 v1, 6, v0
    v_and_b32 v2, 63, v0
    v_and_b32 v3, 15, v2
    v_lshrrev_b32 v4, 4, v2
    s_nop 0
    v_readfirstlane_b32 s52, v1
    s_waitcnt lgkmcnt(0)
    s_mov_b32 s8, s4
    s_and_b32 s9, s5, 0xffff
    s_mov_b32 s10, 268435456
    s_mov_b32 s11, 0x00020000
    s_mov_b32 s16, s16
    s_and_b32 s17, s17, 0xffff
    s_mov_b32 s18, 8388608
    s_mov_b32 s19, 0x00020000
    s_mov_b32 s20, s20
    s_and_b32 s21, s21, 0xffff
    s_mov_b32 s22, 8388608
    s_mov_b32 s23, 0x00020000
    s_mov_b32 s24, s24
    s_and_b32 s25, s25, 0xffff
    s_mov_b32 s26, 8388608
    s_mov_b32 s27, 0x00020000
    s_mov_b32 s28, s28
    s_and_b32 s29, s29, 0xffff
    s_mov_b32 s30, 8388608
    s_mov_b32 s31, 0x00020000
    s_mov_b32 s32, s32
    s_and_b32 s33, s33, 0xffff
    s_mov_b32 s34, 16384
    s_mov_b32 s35, 0x00020000
    v_mov_b32 v128, 0
    v_mov_b32 v129, 0
    v_mov_b32 v130, 0
    v_mov_b32 v131, 0
    v_lshlrev_b32 v5, 4, v0
    ds_write_b128 v5, v[128:131] offset:0
    ds_write_b128 v5, v[128:131] offset:8192
    ds_write_b128 v5, v[128:131] offset:16384
    ds_write_b128 v5, v[128:131] offset:24576
    ds_write_b128 v5, v[128:131] offset:32768
    s_lshl_b32 s53, s51, 20
    v_lshlrev_b32 v6, 16, v4
    v_add_u32 v6, s53, v6
    s_lshl_b32 s54, s50, 8
    v_lshlrev_b32 v7, 1, v3
    v_add_u32 v6, v6, v7
    v_add_u32 v6, s54, v6
    s_mul_i32 s55, s52, 3
    s_add_u32 s55, s55, 0
    s_lshr_b32 s56, s55, 3
    s_and_b32 s57, s55, 7
    s_lshl_b32 s57, s57, 5
    s_cmp_lg_u32 s56, 0
    s_cbranch_scc1 RW_7
    s_add_u32 s58, s57, 0
    buffer_load_ushort v128, v6, s[16:19], s58 offen
    s_add_u32 s58, s57, 8192
    buffer_load_ushort v129, v6, s[16:19], s58 offen
    s_add_u32 s58, s57, 16384
    buffer_load_ushort v130, v6, s[16:19], s58 offen
    s_add_u32 s58, s57, 24576
    buffer_load_ushort v131, v6, s[16:19], s58 offen
    s_add_u32 s58, s57, 32768
    buffer_load_ushort v132, v6, s[16:19], s58 offen
    s_add_u32 s58, s57, 40960
    buffer_load_ushort v133, v6, s[16:19], s58 offen
    s_add_u32 s58, s57, 49152
    buffer_load_ushort v134, v6, s[16:19], s58 offen
    s_add_u32 s58, s57, 57344
    buffer_load_ushort v135, v6, s[16:19], s58 offen
    s_add_u32 s58, s57, 262144
    buffer_load_ushort v136, v6, s[16:19], s58 offen
    s_add_u32 s58, s57, 270336
    buffer_load_ushort v137, v6, s[16:19], s58 offen
    s_add_u32 s58, s57, 278528
    buffer_load_ushort v138, v6, s[16:19], s58 offen
    s_add_u32 s58, s57, 286720
    buffer_load_ushort v139, v6, s[16:19], s58 offen
    s_add_u32 s58, s57, 294912
    buffer_load_ushort v140, v6, s[16:19], s58 offen
    s_add_u32 s58, s57, 303104
    buffer_load_ushort v141, v6, s[16:19], s58 offen
    s_add_u32 s58, s57, 311296
    buffer_load_ushort v142, v6, s[16:19], s58 offen
    s_add_u32 s58, s57, 319488
    buffer_load_ushort v143, v6, s[16:19], s58 offen
    s_add_u32 s58, s57, 524288
    buffer_load_ushort v144, v6, s[16:19], s58 offen
    s_add_u32 s58, s57, 532480
    buffer_load_ushort v145, v6, s[16:19], s58 offen
    s_add_u32 s58, s57, 540672
    buffer_load_ushort v146, v6, s[16:19], s58 offen
    s_add_u32 s58, s57, 548864
    buffer_load_ushort v147, v6, s[16:19], s58 offen
    s_add_u32 s58, s57, 557056
    buffer_load_ushort v148, v6, s[16:19], s58 offen
    s_add_u32 s58, s57, 565248
    buffer_load_ushort v149, v6, s[16:19], s58 offen
    s_add_u32 s58, s57, 573440
    buffer_load_ushort v150, v6, s[16:19], s58 offen
    s_add_u32 s58, s57, 581632
    buffer_load_ushort v151, v6, s[16:19], s58 offen
    s_add_u32 s58, s57, 786432
    buffer_load_ushort v152, v6, s[16:19], s58 offen
    s_add_u32 s58, s57, 794624
    buffer_load_ushort v153, v6, s[16:19], s58 offen
    s_add_u32 s58, s57, 802816
    buffer_load_ushort v154, v6, s[16:19], s58 offen
    s_add_u32 s58, s57, 811008
    buffer_load_ushort v155, v6, s[16:19], s58 offen
    s_add_u32 s58, s57, 819200
    buffer_load_ushort v156, v6, s[16:19], s58 offen
    s_add_u32 s58, s57, 827392
    buffer_load_ushort v157, v6, s[16:19], s58 offen
    s_add_u32 s58, s57, 835584
    buffer_load_ushort v158, v6, s[16:19], s58 offen
    s_add_u32 s58, s57, 843776
    buffer_load_ushort v159, v6, s[16:19], s58 offen
    s_waitcnt vmcnt(0)
    v_lshl_or_b32 v16, v129, 16, v128
    v_lshl_or_b32 v17, v131, 16, v130
    v_lshl_or_b32 v18, v133, 16, v132
    v_lshl_or_b32 v19, v135, 16, v134
    v_lshl_or_b32 v20, v137, 16, v136
    v_lshl_or_b32 v21, v139, 16, v138
    v_lshl_or_b32 v22, v141, 16, v140
    v_lshl_or_b32 v23, v143, 16, v142
    v_lshl_or_b32 v24, v145, 16, v144
    v_lshl_or_b32 v25, v147, 16, v146
    v_lshl_or_b32 v26, v149, 16, v148
    v_lshl_or_b32 v27, v151, 16, v150
    v_lshl_or_b32 v28, v153, 16, v152
    v_lshl_or_b32 v29, v155, 16, v154
    v_lshl_or_b32 v30, v157, 16, v156
    v_lshl_or_b32 v31, v159, 16, v158
RW_7:
    s_cmp_lg_u32 s56, 1
    s_cbranch_scc1 RW_8
    s_add_u32 s58, s57, 0
    buffer_load_ushort v128, v6, s[20:23], s58 offen
    s_add_u32 s58, s57, 8192
    buffer_load_ushort v129, v6, s[20:23], s58 offen
    s_add_u32 s58, s57, 16384
    buffer_load_ushort v130, v6, s[20:23], s58 offen
    s_add_u32 s58, s57, 24576
    buffer_load_ushort v131, v6, s[20:23], s58 offen
    s_add_u32 s58, s57, 32768
    buffer_load_ushort v132, v6, s[20:23], s58 offen
    s_add_u32 s58, s57, 40960
    buffer_load_ushort v133, v6, s[20:23], s58 offen
    s_add_u32 s58, s57, 49152
    buffer_load_ushort v134, v6, s[20:23], s58 offen
    s_add_u32 s58, s57, 57344
    buffer_load_ushort v135, v6, s[20:23], s58 offen
    s_add_u32 s58, s57, 262144
    buffer_load_ushort v136, v6, s[20:23], s58 offen
    s_add_u32 s58, s57, 270336
    buffer_load_ushort v137, v6, s[20:23], s58 offen
    s_add_u32 s58, s57, 278528
    buffer_load_ushort v138, v6, s[20:23], s58 offen
    s_add_u32 s58, s57, 286720
    buffer_load_ushort v139, v6, s[20:23], s58 offen
    s_add_u32 s58, s57, 294912
    buffer_load_ushort v140, v6, s[20:23], s58 offen
    s_add_u32 s58, s57, 303104
    buffer_load_ushort v141, v6, s[20:23], s58 offen
    s_add_u32 s58, s57, 311296
    buffer_load_ushort v142, v6, s[20:23], s58 offen
    s_add_u32 s58, s57, 319488
    buffer_load_ushort v143, v6, s[20:23], s58 offen
    s_add_u32 s58, s57, 524288
    buffer_load_ushort v144, v6, s[20:23], s58 offen
    s_add_u32 s58, s57, 532480
    buffer_load_ushort v145, v6, s[20:23], s58 offen
    s_add_u32 s58, s57, 540672
    buffer_load_ushort v146, v6, s[20:23], s58 offen
    s_add_u32 s58, s57, 548864
    buffer_load_ushort v147, v6, s[20:23], s58 offen
    s_add_u32 s58, s57, 557056
    buffer_load_ushort v148, v6, s[20:23], s58 offen
    s_add_u32 s58, s57, 565248
    buffer_load_ushort v149, v6, s[20:23], s58 offen
    s_add_u32 s58, s57, 573440
    buffer_load_ushort v150, v6, s[20:23], s58 offen
    s_add_u32 s58, s57, 581632
    buffer_load_ushort v151, v6, s[20:23], s58 offen
    s_add_u32 s58, s57, 786432
    buffer_load_ushort v152, v6, s[20:23], s58 offen
    s_add_u32 s58, s57, 794624
    buffer_load_ushort v153, v6, s[20:23], s58 offen
    s_add_u32 s58, s57, 802816
    buffer_load_ushort v154, v6, s[20:23], s58 offen
    s_add_u32 s58, s57, 811008
    buffer_load_ushort v155, v6, s[20:23], s58 offen
    s_add_u32 s58, s57, 819200
    buffer_load_ushort v156, v6, s[20:23], s58 offen
    s_add_u32 s58, s57, 827392
    buffer_load_ushort v157, v6, s[20:23], s58 offen
    s_add_u32 s58, s57, 835584
    buffer_load_ushort v158, v6, s[20:23], s58 offen
    s_add_u32 s58, s57, 843776
    buffer_load_ushort v159, v6, s[20:23], s58 offen
    s_waitcnt vmcnt(0)
    v_lshl_or_b32 v16, v129, 16, v128
    v_lshl_or_b32 v17, v131, 16, v130
    v_lshl_or_b32 v18, v133, 16, v132
    v_lshl_or_b32 v19, v135, 16, v134
    v_lshl_or_b32 v20, v137, 16, v136
    v_lshl_or_b32 v21, v139, 16, v138
    v_lshl_or_b32 v22, v141, 16, v140
    v_lshl_or_b32 v23, v143, 16, v142
    v_lshl_or_b32 v24, v145, 16, v144
    v_lshl_or_b32 v25, v147, 16, v146
    v_lshl_or_b32 v26, v149, 16, v148
    v_lshl_or_b32 v27, v151, 16, v150
    v_lshl_or_b32 v28, v153, 16, v152
    v_lshl_or_b32 v29, v155, 16, v154
    v_lshl_or_b32 v30, v157, 16, v156
    v_lshl_or_b32 v31, v159, 16, v158
RW_8:
    s_cmp_lg_u32 s56, 2
    s_cbranch_scc1 RW_9
    s_add_u32 s58, s57, 0
    buffer_load_ushort v128, v6, s[24:27], s58 offen
    s_add_u32 s58, s57, 8192
    buffer_load_ushort v129, v6, s[24:27], s58 offen
    s_add_u32 s58, s57, 16384
    buffer_load_ushort v130, v6, s[24:27], s58 offen
    s_add_u32 s58, s57, 24576
    buffer_load_ushort v131, v6, s[24:27], s58 offen
    s_add_u32 s58, s57, 32768
    buffer_load_ushort v132, v6, s[24:27], s58 offen
    s_add_u32 s58, s57, 40960
    buffer_load_ushort v133, v6, s[24:27], s58 offen
    s_add_u32 s58, s57, 49152
    buffer_load_ushort v134, v6, s[24:27], s58 offen
    s_add_u32 s58, s57, 57344
    buffer_load_ushort v135, v6, s[24:27], s58 offen
    s_add_u32 s58, s57, 262144
    buffer_load_ushort v136, v6, s[24:27], s58 offen
    s_add_u32 s58, s57, 270336
    buffer_load_ushort v137, v6, s[24:27], s58 offen
    s_add_u32 s58, s57, 278528
    buffer_load_ushort v138, v6, s[24:27], s58 offen
    s_add_u32 s58, s57, 286720
    buffer_load_ushort v139, v6, s[24:27], s58 offen
    s_add_u32 s58, s57, 294912
    buffer_load_ushort v140, v6, s[24:27], s58 offen
    s_add_u32 s58, s57, 303104
    buffer_load_ushort v141, v6, s[24:27], s58 offen
    s_add_u32 s58, s57, 311296
    buffer_load_ushort v142, v6, s[24:27], s58 offen
    s_add_u32 s58, s57, 319488
    buffer_load_ushort v143, v6, s[24:27], s58 offen
    s_add_u32 s58, s57, 524288
    buffer_load_ushort v144, v6, s[24:27], s58 offen
    s_add_u32 s58, s57, 532480
    buffer_load_ushort v145, v6, s[24:27], s58 offen
    s_add_u32 s58, s57, 540672
    buffer_load_ushort v146, v6, s[24:27], s58 offen
    s_add_u32 s58, s57, 548864
    buffer_load_ushort v147, v6, s[24:27], s58 offen
    s_add_u32 s58, s57, 557056
    buffer_load_ushort v148, v6, s[24:27], s58 offen
    s_add_u32 s58, s57, 565248
    buffer_load_ushort v149, v6, s[24:27], s58 offen
    s_add_u32 s58, s57, 573440
    buffer_load_ushort v150, v6, s[24:27], s58 offen
    s_add_u32 s58, s57, 581632
    buffer_load_ushort v151, v6, s[24:27], s58 offen
    s_add_u32 s58, s57, 786432
    buffer_load_ushort v152, v6, s[24:27], s58 offen
    s_add_u32 s58, s57, 794624
    buffer_load_ushort v153, v6, s[24:27], s58 offen
    s_add_u32 s58, s57, 802816
    buffer_load_ushort v154, v6, s[24:27], s58 offen
    s_add_u32 s58, s57, 811008
    buffer_load_ushort v155, v6, s[24:27], s58 offen
    s_add_u32 s58, s57, 819200
    buffer_load_ushort v156, v6, s[24:27], s58 offen
    s_add_u32 s58, s57, 827392
    buffer_load_ushort v157, v6, s[24:27], s58 offen
    s_add_u32 s58, s57, 835584
    buffer_load_ushort v158, v6, s[24:27], s58 offen
    s_add_u32 s58, s57, 843776
    buffer_load_ushort v159, v6, s[24:27], s58 offen
    s_waitcnt vmcnt(0)
    v_lshl_or_b32 v16, v129, 16, v128
    v_lshl_or_b32 v17, v131, 16, v130
    v_lshl_or_b32 v18, v133, 16, v132
    v_lshl_or_b32 v19, v135, 16, v134
    v_lshl_or_b32 v20, v137, 16, v136
    v_lshl_or_b32 v21, v139, 16, v138
    v_lshl_or_b32 v22, v141, 16, v140
    v_lshl_or_b32 v23, v143, 16, v142
    v_lshl_or_b32 v24, v145, 16, v144
    v_lshl_or_b32 v25, v147, 16, v146
    v_lshl_or_b32 v26, v149, 16, v148
    v_lshl_or_b32 v27, v151, 16, v150
    v_lshl_or_b32 v28, v153, 16, v152
    v_lshl_or_b32 v29, v155, 16, v154
    v_lshl_or_b32 v30, v157, 16, v156
    v_lshl_or_b32 v31, v159, 16, v158
RW_9:
    s_mul_i32 s55, s52, 3
    s_add_u32 s55, s55, 1
    s_lshr_b32 s56, s55, 3
    s_and_b32 s57, s55, 7
    s_lshl_b32 s57, s57, 5
    s_cmp_lg_u32 s56, 0
    s_cbranch_scc1 RW_10
    s_add_u32 s58, s57, 0
    buffer_load_ushort v128, v6, s[16:19], s58 offen
    s_add_u32 s58, s57, 8192
    buffer_load_ushort v129, v6, s[16:19], s58 offen
    s_add_u32 s58, s57, 16384
    buffer_load_ushort v130, v6, s[16:19], s58 offen
    s_add_u32 s58, s57, 24576
    buffer_load_ushort v131, v6, s[16:19], s58 offen
    s_add_u32 s58, s57, 32768
    buffer_load_ushort v132, v6, s[16:19], s58 offen
    s_add_u32 s58, s57, 40960
    buffer_load_ushort v133, v6, s[16:19], s58 offen
    s_add_u32 s58, s57, 49152
    buffer_load_ushort v134, v6, s[16:19], s58 offen
    s_add_u32 s58, s57, 57344
    buffer_load_ushort v135, v6, s[16:19], s58 offen
    s_add_u32 s58, s57, 262144
    buffer_load_ushort v136, v6, s[16:19], s58 offen
    s_add_u32 s58, s57, 270336
    buffer_load_ushort v137, v6, s[16:19], s58 offen
    s_add_u32 s58, s57, 278528
    buffer_load_ushort v138, v6, s[16:19], s58 offen
    s_add_u32 s58, s57, 286720
    buffer_load_ushort v139, v6, s[16:19], s58 offen
    s_add_u32 s58, s57, 294912
    buffer_load_ushort v140, v6, s[16:19], s58 offen
    s_add_u32 s58, s57, 303104
    buffer_load_ushort v141, v6, s[16:19], s58 offen
    s_add_u32 s58, s57, 311296
    buffer_load_ushort v142, v6, s[16:19], s58 offen
    s_add_u32 s58, s57, 319488
    buffer_load_ushort v143, v6, s[16:19], s58 offen
    s_add_u32 s58, s57, 524288
    buffer_load_ushort v144, v6, s[16:19], s58 offen
    s_add_u32 s58, s57, 532480
    buffer_load_ushort v145, v6, s[16:19], s58 offen
    s_add_u32 s58, s57, 540672
    buffer_load_ushort v146, v6, s[16:19], s58 offen
    s_add_u32 s58, s57, 548864
    buffer_load_ushort v147, v6, s[16:19], s58 offen
    s_add_u32 s58, s57, 557056
    buffer_load_ushort v148, v6, s[16:19], s58 offen
    s_add_u32 s58, s57, 565248
    buffer_load_ushort v149, v6, s[16:19], s58 offen
    s_add_u32 s58, s57, 573440
    buffer_load_ushort v150, v6, s[16:19], s58 offen
    s_add_u32 s58, s57, 581632
    buffer_load_ushort v151, v6, s[16:19], s58 offen
    s_add_u32 s58, s57, 786432
    buffer_load_ushort v152, v6, s[16:19], s58 offen
    s_add_u32 s58, s57, 794624
    buffer_load_ushort v153, v6, s[16:19], s58 offen
    s_add_u32 s58, s57, 802816
    buffer_load_ushort v154, v6, s[16:19], s58 offen
    s_add_u32 s58, s57, 811008
    buffer_load_ushort v155, v6, s[16:19], s58 offen
    s_add_u32 s58, s57, 819200
    buffer_load_ushort v156, v6, s[16:19], s58 offen
    s_add_u32 s58, s57, 827392
    buffer_load_ushort v157, v6, s[16:19], s58 offen
    s_add_u32 s58, s57, 835584
    buffer_load_ushort v158, v6, s[16:19], s58 offen
    s_add_u32 s58, s57, 843776
    buffer_load_ushort v159, v6, s[16:19], s58 offen
    s_waitcnt vmcnt(0)
    v_lshl_or_b32 v32, v129, 16, v128
    v_lshl_or_b32 v33, v131, 16, v130
    v_lshl_or_b32 v34, v133, 16, v132
    v_lshl_or_b32 v35, v135, 16, v134
    v_lshl_or_b32 v36, v137, 16, v136
    v_lshl_or_b32 v37, v139, 16, v138
    v_lshl_or_b32 v38, v141, 16, v140
    v_lshl_or_b32 v39, v143, 16, v142
    v_lshl_or_b32 v40, v145, 16, v144
    v_lshl_or_b32 v41, v147, 16, v146
    v_lshl_or_b32 v42, v149, 16, v148
    v_lshl_or_b32 v43, v151, 16, v150
    v_lshl_or_b32 v44, v153, 16, v152
    v_lshl_or_b32 v45, v155, 16, v154
    v_lshl_or_b32 v46, v157, 16, v156
    v_lshl_or_b32 v47, v159, 16, v158
RW_10:
    s_cmp_lg_u32 s56, 1
    s_cbranch_scc1 RW_11
    s_add_u32 s58, s57, 0
    buffer_load_ushort v128, v6, s[20:23], s58 offen
    s_add_u32 s58, s57, 8192
    buffer_load_ushort v129, v6, s[20:23], s58 offen
    s_add_u32 s58, s57, 16384
    buffer_load_ushort v130, v6, s[20:23], s58 offen
    s_add_u32 s58, s57, 24576
    buffer_load_ushort v131, v6, s[20:23], s58 offen
    s_add_u32 s58, s57, 32768
    buffer_load_ushort v132, v6, s[20:23], s58 offen
    s_add_u32 s58, s57, 40960
    buffer_load_ushort v133, v6, s[20:23], s58 offen
    s_add_u32 s58, s57, 49152
    buffer_load_ushort v134, v6, s[20:23], s58 offen
    s_add_u32 s58, s57, 57344
    buffer_load_ushort v135, v6, s[20:23], s58 offen
    s_add_u32 s58, s57, 262144
    buffer_load_ushort v136, v6, s[20:23], s58 offen
    s_add_u32 s58, s57, 270336
    buffer_load_ushort v137, v6, s[20:23], s58 offen
    s_add_u32 s58, s57, 278528
    buffer_load_ushort v138, v6, s[20:23], s58 offen
    s_add_u32 s58, s57, 286720
    buffer_load_ushort v139, v6, s[20:23], s58 offen
    s_add_u32 s58, s57, 294912
    buffer_load_ushort v140, v6, s[20:23], s58 offen
    s_add_u32 s58, s57, 303104
    buffer_load_ushort v141, v6, s[20:23], s58 offen
    s_add_u32 s58, s57, 311296
    buffer_load_ushort v142, v6, s[20:23], s58 offen
    s_add_u32 s58, s57, 319488
    buffer_load_ushort v143, v6, s[20:23], s58 offen
    s_add_u32 s58, s57, 524288
    buffer_load_ushort v144, v6, s[20:23], s58 offen
    s_add_u32 s58, s57, 532480
    buffer_load_ushort v145, v6, s[20:23], s58 offen
    s_add_u32 s58, s57, 540672
    buffer_load_ushort v146, v6, s[20:23], s58 offen
    s_add_u32 s58, s57, 548864
    buffer_load_ushort v147, v6, s[20:23], s58 offen
    s_add_u32 s58, s57, 557056
    buffer_load_ushort v148, v6, s[20:23], s58 offen
    s_add_u32 s58, s57, 565248
    buffer_load_ushort v149, v6, s[20:23], s58 offen
    s_add_u32 s58, s57, 573440
    buffer_load_ushort v150, v6, s[20:23], s58 offen
    s_add_u32 s58, s57, 581632
    buffer_load_ushort v151, v6, s[20:23], s58 offen
    s_add_u32 s58, s57, 786432
    buffer_load_ushort v152, v6, s[20:23], s58 offen
    s_add_u32 s58, s57, 794624
    buffer_load_ushort v153, v6, s[20:23], s58 offen
    s_add_u32 s58, s57, 802816
    buffer_load_ushort v154, v6, s[20:23], s58 offen
    s_add_u32 s58, s57, 811008
    buffer_load_ushort v155, v6, s[20:23], s58 offen
    s_add_u32 s58, s57, 819200
    buffer_load_ushort v156, v6, s[20:23], s58 offen
    s_add_u32 s58, s57, 827392
    buffer_load_ushort v157, v6, s[20:23], s58 offen
    s_add_u32 s58, s57, 835584
    buffer_load_ushort v158, v6, s[20:23], s58 offen
    s_add_u32 s58, s57, 843776
    buffer_load_ushort v159, v6, s[20:23], s58 offen
    s_waitcnt vmcnt(0)
    v_lshl_or_b32 v32, v129, 16, v128
    v_lshl_or_b32 v33, v131, 16, v130
    v_lshl_or_b32 v34, v133, 16, v132
    v_lshl_or_b32 v35, v135, 16, v134
    v_lshl_or_b32 v36, v137, 16, v136
    v_lshl_or_b32 v37, v139, 16, v138
    v_lshl_or_b32 v38, v141, 16, v140
    v_lshl_or_b32 v39, v143, 16, v142
    v_lshl_or_b32 v40, v145, 16, v144
    v_lshl_or_b32 v41, v147, 16, v146
    v_lshl_or_b32 v42, v149, 16, v148
    v_lshl_or_b32 v43, v151, 16, v150
    v_lshl_or_b32 v44, v153, 16, v152
    v_lshl_or_b32 v45, v155, 16, v154
    v_lshl_or_b32 v46, v157, 16, v156
    v_lshl_or_b32 v47, v159, 16, v158
RW_11:
    s_cmp_lg_u32 s56, 2
    s_cbranch_scc1 RW_12
    s_add_u32 s58, s57, 0
    buffer_load_ushort v128, v6, s[24:27], s58 offen
    s_add_u32 s58, s57, 8192
    buffer_load_ushort v129, v6, s[24:27], s58 offen
    s_add_u32 s58, s57, 16384
    buffer_load_ushort v130, v6, s[24:27], s58 offen
    s_add_u32 s58, s57, 24576
    buffer_load_ushort v131, v6, s[24:27], s58 offen
    s_add_u32 s58, s57, 32768
    buffer_load_ushort v132, v6, s[24:27], s58 offen
    s_add_u32 s58, s57, 40960
    buffer_load_ushort v133, v6, s[24:27], s58 offen
    s_add_u32 s58, s57, 49152
    buffer_load_ushort v134, v6, s[24:27], s58 offen
    s_add_u32 s58, s57, 57344
    buffer_load_ushort v135, v6, s[24:27], s58 offen
    s_add_u32 s58, s57, 262144
    buffer_load_ushort v136, v6, s[24:27], s58 offen
    s_add_u32 s58, s57, 270336
    buffer_load_ushort v137, v6, s[24:27], s58 offen
    s_add_u32 s58, s57, 278528
    buffer_load_ushort v138, v6, s[24:27], s58 offen
    s_add_u32 s58, s57, 286720
    buffer_load_ushort v139, v6, s[24:27], s58 offen
    s_add_u32 s58, s57, 294912
    buffer_load_ushort v140, v6, s[24:27], s58 offen
    s_add_u32 s58, s57, 303104
    buffer_load_ushort v141, v6, s[24:27], s58 offen
    s_add_u32 s58, s57, 311296
    buffer_load_ushort v142, v6, s[24:27], s58 offen
    s_add_u32 s58, s57, 319488
    buffer_load_ushort v143, v6, s[24:27], s58 offen
    s_add_u32 s58, s57, 524288
    buffer_load_ushort v144, v6, s[24:27], s58 offen
    s_add_u32 s58, s57, 532480
    buffer_load_ushort v145, v6, s[24:27], s58 offen
    s_add_u32 s58, s57, 540672
    buffer_load_ushort v146, v6, s[24:27], s58 offen
    s_add_u32 s58, s57, 548864
    buffer_load_ushort v147, v6, s[24:27], s58 offen
    s_add_u32 s58, s57, 557056
    buffer_load_ushort v148, v6, s[24:27], s58 offen
    s_add_u32 s58, s57, 565248
    buffer_load_ushort v149, v6, s[24:27], s58 offen
    s_add_u32 s58, s57, 573440
    buffer_load_ushort v150, v6, s[24:27], s58 offen
    s_add_u32 s58, s57, 581632
    buffer_load_ushort v151, v6, s[24:27], s58 offen
    s_add_u32 s58, s57, 786432
    buffer_load_ushort v152, v6, s[24:27], s58 offen
    s_add_u32 s58, s57, 794624
    buffer_load_ushort v153, v6, s[24:27], s58 offen
    s_add_u32 s58, s57, 802816
    buffer_load_ushort v154, v6, s[24:27], s58 offen
    s_add_u32 s58, s57, 811008
    buffer_load_ushort v155, v6, s[24:27], s58 offen
    s_add_u32 s58, s57, 819200
    buffer_load_ushort v156, v6, s[24:27], s58 offen
    s_add_u32 s58, s57, 827392
    buffer_load_ushort v157, v6, s[24:27], s58 offen
    s_add_u32 s58, s57, 835584
    buffer_load_ushort v158, v6, s[24:27], s58 offen
    s_add_u32 s58, s57, 843776
    buffer_load_ushort v159, v6, s[24:27], s58 offen
    s_waitcnt vmcnt(0)
    v_lshl_or_b32 v32, v129, 16, v128
    v_lshl_or_b32 v33, v131, 16, v130
    v_lshl_or_b32 v34, v133, 16, v132
    v_lshl_or_b32 v35, v135, 16, v134
    v_lshl_or_b32 v36, v137, 16, v136
    v_lshl_or_b32 v37, v139, 16, v138
    v_lshl_or_b32 v38, v141, 16, v140
    v_lshl_or_b32 v39, v143, 16, v142
    v_lshl_or_b32 v40, v145, 16, v144
    v_lshl_or_b32 v41, v147, 16, v146
    v_lshl_or_b32 v42, v149, 16, v148
    v_lshl_or_b32 v43, v151, 16, v150
    v_lshl_or_b32 v44, v153, 16, v152
    v_lshl_or_b32 v45, v155, 16, v154
    v_lshl_or_b32 v46, v157, 16, v156
    v_lshl_or_b32 v47, v159, 16, v158
RW_12:
    s_mul_i32 s55, s52, 3
    s_add_u32 s55, s55, 2
    s_lshr_b32 s56, s55, 3
    s_and_b32 s57, s55, 7
    s_lshl_b32 s57, s57, 5
    s_cmp_lg_u32 s56, 0
    s_cbranch_scc1 RW_13
    s_add_u32 s58, s57, 0
    buffer_load_ushort v128, v6, s[16:19], s58 offen
    s_add_u32 s58, s57, 8192
    buffer_load_ushort v129, v6, s[16:19], s58 offen
    s_add_u32 s58, s57, 16384
    buffer_load_ushort v130, v6, s[16:19], s58 offen
    s_add_u32 s58, s57, 24576
    buffer_load_ushort v131, v6, s[16:19], s58 offen
    s_add_u32 s58, s57, 32768
    buffer_load_ushort v132, v6, s[16:19], s58 offen
    s_add_u32 s58, s57, 40960
    buffer_load_ushort v133, v6, s[16:19], s58 offen
    s_add_u32 s58, s57, 49152
    buffer_load_ushort v134, v6, s[16:19], s58 offen
    s_add_u32 s58, s57, 57344
    buffer_load_ushort v135, v6, s[16:19], s58 offen
    s_add_u32 s58, s57, 262144
    buffer_load_ushort v136, v6, s[16:19], s58 offen
    s_add_u32 s58, s57, 270336
    buffer_load_ushort v137, v6, s[16:19], s58 offen
    s_add_u32 s58, s57, 278528
    buffer_load_ushort v138, v6, s[16:19], s58 offen
    s_add_u32 s58, s57, 286720
    buffer_load_ushort v139, v6, s[16:19], s58 offen
    s_add_u32 s58, s57, 294912
    buffer_load_ushort v140, v6, s[16:19], s58 offen
    s_add_u32 s58, s57, 303104
    buffer_load_ushort v141, v6, s[16:19], s58 offen
    s_add_u32 s58, s57, 311296
    buffer_load_ushort v142, v6, s[16:19], s58 offen
    s_add_u32 s58, s57, 319488
    buffer_load_ushort v143, v6, s[16:19], s58 offen
    s_add_u32 s58, s57, 524288
    buffer_load_ushort v144, v6, s[16:19], s58 offen
    s_add_u32 s58, s57, 532480
    buffer_load_ushort v145, v6, s[16:19], s58 offen
    s_add_u32 s58, s57, 540672
    buffer_load_ushort v146, v6, s[16:19], s58 offen
    s_add_u32 s58, s57, 548864
    buffer_load_ushort v147, v6, s[16:19], s58 offen
    s_add_u32 s58, s57, 557056
    buffer_load_ushort v148, v6, s[16:19], s58 offen
    s_add_u32 s58, s57, 565248
    buffer_load_ushort v149, v6, s[16:19], s58 offen
    s_add_u32 s58, s57, 573440
    buffer_load_ushort v150, v6, s[16:19], s58 offen
    s_add_u32 s58, s57, 581632
    buffer_load_ushort v151, v6, s[16:19], s58 offen
    s_add_u32 s58, s57, 786432
    buffer_load_ushort v152, v6, s[16:19], s58 offen
    s_add_u32 s58, s57, 794624
    buffer_load_ushort v153, v6, s[16:19], s58 offen
    s_add_u32 s58, s57, 802816
    buffer_load_ushort v154, v6, s[16:19], s58 offen
    s_add_u32 s58, s57, 811008
    buffer_load_ushort v155, v6, s[16:19], s58 offen
    s_add_u32 s58, s57, 819200
    buffer_load_ushort v156, v6, s[16:19], s58 offen
    s_add_u32 s58, s57, 827392
    buffer_load_ushort v157, v6, s[16:19], s58 offen
    s_add_u32 s58, s57, 835584
    buffer_load_ushort v158, v6, s[16:19], s58 offen
    s_add_u32 s58, s57, 843776
    buffer_load_ushort v159, v6, s[16:19], s58 offen
    s_waitcnt vmcnt(0)
    v_lshl_or_b32 v48, v129, 16, v128
    v_lshl_or_b32 v49, v131, 16, v130
    v_lshl_or_b32 v50, v133, 16, v132
    v_lshl_or_b32 v51, v135, 16, v134
    v_lshl_or_b32 v52, v137, 16, v136
    v_lshl_or_b32 v53, v139, 16, v138
    v_lshl_or_b32 v54, v141, 16, v140
    v_lshl_or_b32 v55, v143, 16, v142
    v_lshl_or_b32 v56, v145, 16, v144
    v_lshl_or_b32 v57, v147, 16, v146
    v_lshl_or_b32 v58, v149, 16, v148
    v_lshl_or_b32 v59, v151, 16, v150
    v_lshl_or_b32 v60, v153, 16, v152
    v_lshl_or_b32 v61, v155, 16, v154
    v_lshl_or_b32 v62, v157, 16, v156
    v_lshl_or_b32 v63, v159, 16, v158
RW_13:
    s_cmp_lg_u32 s56, 1
    s_cbranch_scc1 RW_14
    s_add_u32 s58, s57, 0
    buffer_load_ushort v128, v6, s[20:23], s58 offen
    s_add_u32 s58, s57, 8192
    buffer_load_ushort v129, v6, s[20:23], s58 offen
    s_add_u32 s58, s57, 16384
    buffer_load_ushort v130, v6, s[20:23], s58 offen
    s_add_u32 s58, s57, 24576
    buffer_load_ushort v131, v6, s[20:23], s58 offen
    s_add_u32 s58, s57, 32768
    buffer_load_ushort v132, v6, s[20:23], s58 offen
    s_add_u32 s58, s57, 40960
    buffer_load_ushort v133, v6, s[20:23], s58 offen
    s_add_u32 s58, s57, 49152
    buffer_load_ushort v134, v6, s[20:23], s58 offen
    s_add_u32 s58, s57, 57344
    buffer_load_ushort v135, v6, s[20:23], s58 offen
    s_add_u32 s58, s57, 262144
    buffer_load_ushort v136, v6, s[20:23], s58 offen
    s_add_u32 s58, s57, 270336
    buffer_load_ushort v137, v6, s[20:23], s58 offen
    s_add_u32 s58, s57, 278528
    buffer_load_ushort v138, v6, s[20:23], s58 offen
    s_add_u32 s58, s57, 286720
    buffer_load_ushort v139, v6, s[20:23], s58 offen
    s_add_u32 s58, s57, 294912
    buffer_load_ushort v140, v6, s[20:23], s58 offen
    s_add_u32 s58, s57, 303104
    buffer_load_ushort v141, v6, s[20:23], s58 offen
    s_add_u32 s58, s57, 311296
    buffer_load_ushort v142, v6, s[20:23], s58 offen
    s_add_u32 s58, s57, 319488
    buffer_load_ushort v143, v6, s[20:23], s58 offen
    s_add_u32 s58, s57, 524288
    buffer_load_ushort v144, v6, s[20:23], s58 offen
    s_add_u32 s58, s57, 532480
    buffer_load_ushort v145, v6, s[20:23], s58 offen
    s_add_u32 s58, s57, 540672
    buffer_load_ushort v146, v6, s[20:23], s58 offen
    s_add_u32 s58, s57, 548864
    buffer_load_ushort v147, v6, s[20:23], s58 offen
    s_add_u32 s58, s57, 557056
    buffer_load_ushort v148, v6, s[20:23], s58 offen
    s_add_u32 s58, s57, 565248
    buffer_load_ushort v149, v6, s[20:23], s58 offen
    s_add_u32 s58, s57, 573440
    buffer_load_ushort v150, v6, s[20:23], s58 offen
    s_add_u32 s58, s57, 581632
    buffer_load_ushort v151, v6, s[20:23], s58 offen
    s_add_u32 s58, s57, 786432
    buffer_load_ushort v152, v6, s[20:23], s58 offen
    s_add_u32 s58, s57, 794624
    buffer_load_ushort v153, v6, s[20:23], s58 offen
    s_add_u32 s58, s57, 802816
    buffer_load_ushort v154, v6, s[20:23], s58 offen
    s_add_u32 s58, s57, 811008
    buffer_load_ushort v155, v6, s[20:23], s58 offen
    s_add_u32 s58, s57, 819200
    buffer_load_ushort v156, v6, s[20:23], s58 offen
    s_add_u32 s58, s57, 827392
    buffer_load_ushort v157, v6, s[20:23], s58 offen
    s_add_u32 s58, s57, 835584
    buffer_load_ushort v158, v6, s[20:23], s58 offen
    s_add_u32 s58, s57, 843776
    buffer_load_ushort v159, v6, s[20:23], s58 offen
    s_waitcnt vmcnt(0)
    v_lshl_or_b32 v48, v129, 16, v128
    v_lshl_or_b32 v49, v131, 16, v130
    v_lshl_or_b32 v50, v133, 16, v132
    v_lshl_or_b32 v51, v135, 16, v134
    v_lshl_or_b32 v52, v137, 16, v136
    v_lshl_or_b32 v53, v139, 16, v138
    v_lshl_or_b32 v54, v141, 16, v140
    v_lshl_or_b32 v55, v143, 16, v142
    v_lshl_or_b32 v56, v145, 16, v144
    v_lshl_or_b32 v57, v147, 16, v146
    v_lshl_or_b32 v58, v149, 16, v148
    v_lshl_or_b32 v59, v151, 16, v150
    v_lshl_or_b32 v60, v153, 16, v152
    v_lshl_or_b32 v61, v155, 16, v154
    v_lshl_or_b32 v62, v157, 16, v156
    v_lshl_or_b32 v63, v159, 16, v158
RW_14:
    s_cmp_lg_u32 s56, 2
    s_cbranch_scc1 RW_15
    s_add_u32 s58, s57, 0
    buffer_load_ushort v128, v6, s[24:27], s58 offen
    s_add_u32 s58, s57, 8192
    buffer_load_ushort v129, v6, s[24:27], s58 offen
    s_add_u32 s58, s57, 16384
    buffer_load_ushort v130, v6, s[24:27], s58 offen
    s_add_u32 s58, s57, 24576
    buffer_load_ushort v131, v6, s[24:27], s58 offen
    s_add_u32 s58, s57, 32768
    buffer_load_ushort v132, v6, s[24:27], s58 offen
    s_add_u32 s58, s57, 40960
    buffer_load_ushort v133, v6, s[24:27], s58 offen
    s_add_u32 s58, s57, 49152
    buffer_load_ushort v134, v6, s[24:27], s58 offen
    s_add_u32 s58, s57, 57344
    buffer_load_ushort v135, v6, s[24:27], s58 offen
    s_add_u32 s58, s57, 262144
    buffer_load_ushort v136, v6, s[24:27], s58 offen
    s_add_u32 s58, s57, 270336
    buffer_load_ushort v137, v6, s[24:27], s58 offen
    s_add_u32 s58, s57, 278528
    buffer_load_ushort v138, v6, s[24:27], s58 offen
    s_add_u32 s58, s57, 286720
    buffer_load_ushort v139, v6, s[24:27], s58 offen
    s_add_u32 s58, s57, 294912
    buffer_load_ushort v140, v6, s[24:27], s58 offen
    s_add_u32 s58, s57, 303104
    buffer_load_ushort v141, v6, s[24:27], s58 offen
    s_add_u32 s58, s57, 311296
    buffer_load_ushort v142, v6, s[24:27], s58 offen
    s_add_u32 s58, s57, 319488
    buffer_load_ushort v143, v6, s[24:27], s58 offen
    s_add_u32 s58, s57, 524288
    buffer_load_ushort v144, v6, s[24:27], s58 offen
    s_add_u32 s58, s57, 532480
    buffer_load_ushort v145, v6, s[24:27], s58 offen
    s_add_u32 s58, s57, 540672
    buffer_load_ushort v146, v6, s[24:27], s58 offen
    s_add_u32 s58, s57, 548864
    buffer_load_ushort v147, v6, s[24:27], s58 offen
    s_add_u32 s58, s57, 557056
    buffer_load_ushort v148, v6, s[24:27], s58 offen
    s_add_u32 s58, s57, 565248
    buffer_load_ushort v149, v6, s[24:27], s58 offen
    s_add_u32 s58, s57, 573440
    buffer_load_ushort v150, v6, s[24:27], s58 offen
    s_add_u32 s58, s57, 581632
    buffer_load_ushort v151, v6, s[24:27], s58 offen
    s_add_u32 s58, s57, 786432
    buffer_load_ushort v152, v6, s[24:27], s58 offen
    s_add_u32 s58, s57, 794624
    buffer_load_ushort v153, v6, s[24:27], s58 offen
    s_add_u32 s58, s57, 802816
    buffer_load_ushort v154, v6, s[24:27], s58 offen
    s_add_u32 s58, s57, 811008
    buffer_load_ushort v155, v6, s[24:27], s58 offen
    s_add_u32 s58, s57, 819200
    buffer_load_ushort v156, v6, s[24:27], s58 offen
    s_add_u32 s58, s57, 827392
    buffer_load_ushort v157, v6, s[24:27], s58 offen
    s_add_u32 s58, s57, 835584
    buffer_load_ushort v158, v6, s[24:27], s58 offen
    s_add_u32 s58, s57, 843776
    buffer_load_ushort v159, v6, s[24:27], s58 offen
    s_waitcnt vmcnt(0)
    v_lshl_or_b32 v48, v129, 16, v128
    v_lshl_or_b32 v49, v131, 16, v130
    v_lshl_or_b32 v50, v133, 16, v132
    v_lshl_or_b32 v51, v135, 16, v134
    v_lshl_or_b32 v52, v137, 16, v136
    v_lshl_or_b32 v53, v139, 16, v138
    v_lshl_or_b32 v54, v141, 16, v140
    v_lshl_or_b32 v55, v143, 16, v142
    v_lshl_or_b32 v56, v145, 16, v144
    v_lshl_or_b32 v57, v147, 16, v146
    v_lshl_or_b32 v58, v149, 16, v148
    v_lshl_or_b32 v59, v151, 16, v150
    v_lshl_or_b32 v60, v153, 16, v152
    v_lshl_or_b32 v61, v155, 16, v154
    v_lshl_or_b32 v62, v157, 16, v156
    v_lshl_or_b32 v63, v159, 16, v158
RW_15:
    s_lshl_b32 s55, s50, 18
    v_lshlrev_b32 v6, 14, v4
    v_add_u32 v6, s55, v6
    s_lshl_b32 s56, s51, 8
    s_lshl_b32 s57, s52, 5
    s_add_u32 s56, s56, s57
    v_add_u32 v6, s56, v6
    v_lshlrev_b32 v7, 1, v3
    v_add_u32 v6, v6, v7
    s_mov_b32 s58, 0
    buffer_load_ushort v128, v6, s[28:31], s58 offen
    s_mov_b32 s58, 2048
    buffer_load_ushort v129, v6, s[28:31], s58 offen
    s_mov_b32 s58, 4096
    buffer_load_ushort v130, v6, s[28:31], s58 offen
    s_mov_b32 s58, 6144
    buffer_load_ushort v131, v6, s[28:31], s58 offen
    s_mov_b32 s58, 8192
    buffer_load_ushort v132, v6, s[28:31], s58 offen
    s_mov_b32 s58, 10240
    buffer_load_ushort v133, v6, s[28:31], s58 offen
    s_mov_b32 s58, 12288
    buffer_load_ushort v134, v6, s[28:31], s58 offen
    s_mov_b32 s58, 14336
    buffer_load_ushort v135, v6, s[28:31], s58 offen
    s_mov_b32 s58, 65536
    buffer_load_ushort v136, v6, s[28:31], s58 offen
    s_mov_b32 s58, 67584
    buffer_load_ushort v137, v6, s[28:31], s58 offen
    s_mov_b32 s58, 69632
    buffer_load_ushort v138, v6, s[28:31], s58 offen
    s_mov_b32 s58, 71680
    buffer_load_ushort v139, v6, s[28:31], s58 offen
    s_mov_b32 s58, 73728
    buffer_load_ushort v140, v6, s[28:31], s58 offen
    s_mov_b32 s58, 75776
    buffer_load_ushort v141, v6, s[28:31], s58 offen
    s_mov_b32 s58, 77824
    buffer_load_ushort v142, v6, s[28:31], s58 offen
    s_mov_b32 s58, 79872
    buffer_load_ushort v143, v6, s[28:31], s58 offen
    s_mov_b32 s58, 131072
    buffer_load_ushort v144, v6, s[28:31], s58 offen
    s_mov_b32 s58, 133120
    buffer_load_ushort v145, v6, s[28:31], s58 offen
    s_mov_b32 s58, 135168
    buffer_load_ushort v146, v6, s[28:31], s58 offen
    s_mov_b32 s58, 137216
    buffer_load_ushort v147, v6, s[28:31], s58 offen
    s_mov_b32 s58, 139264
    buffer_load_ushort v148, v6, s[28:31], s58 offen
    s_mov_b32 s58, 141312
    buffer_load_ushort v149, v6, s[28:31], s58 offen
    s_mov_b32 s58, 143360
    buffer_load_ushort v150, v6, s[28:31], s58 offen
    s_mov_b32 s58, 145408
    buffer_load_ushort v151, v6, s[28:31], s58 offen
    s_mov_b32 s58, 196608
    buffer_load_ushort v152, v6, s[28:31], s58 offen
    s_mov_b32 s58, 198656
    buffer_load_ushort v153, v6, s[28:31], s58 offen
    s_mov_b32 s58, 200704
    buffer_load_ushort v154, v6, s[28:31], s58 offen
    s_mov_b32 s58, 202752
    buffer_load_ushort v155, v6, s[28:31], s58 offen
    s_mov_b32 s58, 204800
    buffer_load_ushort v156, v6, s[28:31], s58 offen
    s_mov_b32 s58, 206848
    buffer_load_ushort v157, v6, s[28:31], s58 offen
    s_mov_b32 s58, 208896
    buffer_load_ushort v158, v6, s[28:31], s58 offen
    s_mov_b32 s58, 210944
    buffer_load_ushort v159, v6, s[28:31], s58 offen
    s_waitcnt vmcnt(0)
    v_lshl_or_b32 v64, v129, 16, v128
    v_lshl_or_b32 v65, v131, 16, v130
    v_lshl_or_b32 v66, v133, 16, v132
    v_lshl_or_b32 v67, v135, 16, v134
    v_lshl_or_b32 v68, v137, 16, v136
    v_lshl_or_b32 v69, v139, 16, v138
    v_lshl_or_b32 v70, v141, 16, v140
    v_lshl_or_b32 v71, v143, 16, v142
    v_lshl_or_b32 v72, v145, 16, v144
    v_lshl_or_b32 v73, v147, 16, v146
    v_lshl_or_b32 v74, v149, 16, v148
    v_lshl_or_b32 v75, v151, 16, v150
    v_lshl_or_b32 v76, v153, 16, v152
    v_lshl_or_b32 v77, v155, 16, v154
    v_lshl_or_b32 v78, v157, 16, v156
    v_lshl_or_b32 v79, v159, 16, v158
    s_waitcnt lgkmcnt(0)
    s_barrier
    v_cmp_gt_u32 vcc, 128, v0
    s_and_saveexec_b64 s[64:65], vcc
    s_cbranch_execz R_m0done
    v_lshrrev_b32 v6, 4, v0
    v_and_b32 v7, 15, v0
    v_lshlrev_b32 v8, 11, v6
    v_lshlrev_b32 v9, 4, v7
    v_add_u32 v8, v8, v9
    s_lshl_b32 s55, s51, 8
    buffer_load_dwordx4 v[128:131], v8, s[32:35], s55 offen
    v_mul_u32_u24 v8, 272, v6
    v_add_u32 v8, v8, v9
    s_waitcnt vmcnt(0)
    ds_write_b128 v8, v[128:131] offset:12544
R_m0done:
    s_mov_b64 exec, s[64:65]
    s_waitcnt lgkmcnt(0)
    s_barrier
    v_mul_u32_u24 v8, 272, v3
    v_lshlrev_b32 v9, 4, v4
    v_add_u32 v8, v8, v9
    v_mul_u32_u24 v9, 784, v3
    v_lshlrev_b32 v10, 4, v4
    v_add_u32 v9, v9, v10
    v_mul_u32_u24 v10, 768, v3
    v_lshlrev_b32 v11, 3, v4
    v_add_u32 v10, v10, v11
    v_lshlrev_b32 v11, 8, v3
    v_lshlrev_b32 v12, 3, v4
    v_add_u32 v11, v11, v12
    s_lshl_b32 s55, s52, 5
    v_add_u32 v11, s55, v11
    v_lshrrev_b32 v13, 2, v3
    v_lshlrev_b32 v12, 2, v4
    v_add_u32 v12, v12, v13
    v_mul_u32_u24 v12, 288, v12
    v_and_b32 v13, 3, v3
    v_lshlrev_b32 v13, 3, v13
    v_add_u32 v12, v12, v13
    s_lshl_b32 s55, s52, 5
    v_add_u32 v12, s55, v12
    v_mul_u32_u24 v13, 272, v3
    v_lshlrev_b32 v14, 3, v4
    v_add_u32 v13, v13, v14
    v_add_u32 v13, s55, v13
    v_xor_b32 v14, 16, v2
    v_lshlrev_b32 v14, 2, v14
    v_xor_b32 v15, 32, v2
    v_lshlrev_b32 v15, 2, v15
    v_lshrrev_b32 v91, 4, v0
    v_and_b32 v92, 15, v0
    v_lshlrev_b32 v88, 13, v91
    v_lshlrev_b32 v93, 4, v92
    v_add_u32 v88, v88, v93
    v_mul_u32_u24 v89, 272, v91
    v_add_u32 v89, v89, v93
    v_mul_u32_u24 v90, 288, v91
    v_add_u32 v90, v90, v93
    s_lshl_b32 s68, s50, 8
    s_add_u32 s68, s68, 20971520
    buffer_load_dwordx4 v[80:83], v88, s[8:11], s68 offen
    s_add_u32 s57, s68, 16777216
    buffer_load_dwordx4 v[84:87], v88, s[8:11], s57 offen
    s_mov_b32 s60, 0
R_step:
    s_and_b32 s61, s60, 1
    s_waitcnt lgkmcnt(0)
    ds_read_b128 v[96:99], v8 offset:12544
    ds_read_b128 v[100:103], v8 offset:12608
    ds_read_b128 v[104:107], v8 offset:12672
    ds_read_b128 v[108:111], v8 offset:12736
    s_waitcnt vmcnt(0)
    ds_write_b128 v89, v[80:83] offset:39680
    ds_write_b128 v90, v[84:87] offset:25856
    s_waitcnt lgkmcnt(0)
    v_mov_b32 v128, 0
    v_mov_b32 v129, 0
    v_mov_b32 v130, 0
    v_mov_b32 v131, 0
    v_mov_b32 v132, 0
    v_mov_b32 v133, 0
    v_mov_b32 v134, 0
    v_mov_b32 v135, 0
    v_mov_b32 v136, 0
    v_mov_b32 v137, 0
    v_mov_b32 v138, 0
    v_mov_b32 v139, 0
    s_nop 1
    v_mfma_f32_16x16x32_bf16 v[128:131], v[16:19], v[96:99], v[128:131]
    v_mfma_f32_16x16x32_bf16 v[132:135], v[32:35], v[96:99], v[132:135]
    v_mfma_f32_16x16x32_bf16 v[136:139], v[48:51], v[96:99], v[136:139]
    v_mfma_f32_16x16x32_bf16 v[128:131], v[20:23], v[100:103], v[128:131]
    v_mfma_f32_16x16x32_bf16 v[132:135], v[36:39], v[100:103], v[132:135]
    v_mfma_f32_16x16x32_bf16 v[136:139], v[52:55], v[100:103], v[136:139]
    v_mfma_f32_16x16x32_bf16 v[128:131], v[24:27], v[104:107], v[128:131]
    v_mfma_f32_16x16x32_bf16 v[132:135], v[40:43], v[104:107], v[132:135]
    v_mfma_f32_16x16x32_bf16 v[136:139], v[56:59], v[104:107], v[136:139]
    v_mfma_f32_16x16x32_bf16 v[128:131], v[28:31], v[108:111], v[128:131]
    v_mfma_f32_16x16x32_bf16 v[132:135], v[44:47], v[108:111], v[132:135]
    v_mfma_f32_16x16x32_bf16 v[136:139], v[60:63], v[108:111], v[136:139]
    s_lshl_b32 s55, s61, 5
    s_add_u32 s55, s55, s50
    s_lshl_b32 s55, s55, 3
    s_add_u32 s55, s55, s51
    s_mul_i32 s55, s55, 6144
    s_add_u32 s55, s55, 96468992
    s_mul_i32 s56, s52, 96
    s_add_u32 s55, s55, s56
    v_cmp_gt_u32 vcc, 8, v3
    s_nop 4
    s_and_saveexec_b64 s[64:65], vcc
    v_cvt_pk_bf16_f32 v128, v128, v129
    v_cvt_pk_bf16_f32 v129, v130, v131
    buffer_store_dwordx2 v[128:129], v10, s[8:11], s55 offen offset:0 sc1
    v_cvt_pk_bf16_f32 v132, v132, v133
    v_cvt_pk_bf16_f32 v133, v134, v135
    buffer_store_dwordx2 v[132:133], v10, s[8:11], s55 offen offset:32 sc1
    v_cvt_pk_bf16_f32 v136, v136, v137
    v_cvt_pk_bf16_f32 v137, v138, v139
    buffer_store_dwordx2 v[136:137], v10, s[8:11], s55 offen offset:64 sc1
    s_mov_b64 exec, s[64:65]
    s_waitcnt vmcnt(0)
    s_barrier
    s_add_u32 s62, s60, 1
    s_cmp_lg_u32 s52, 0
    s_cbranch_scc1 R_pa_done
    s_lshl_b32 s55, s50, 3
    s_add_u32 s56, s55, s51
    s_lshl_b32 s56, s56, 7
    s_add_u32 s56, s56, 109051904
    v_mov_b32 v112, s62
    v_mov_b32 v113, 0
    v_cmp_gt_u32 vcc, 1, v2
    s_and_saveexec_b64 s[64:65], vcc
    buffer_store_dword v112, v113, s[8:11], s56 offen sc1
    s_mov_b64 exec, s[64:65]
    v_cmp_gt_u32 vcc, 8, v2
    s_and_saveexec_b64 s[64:65], vcc
    s_lshl_b32 s56, s55, 7
    s_add_u32 s56, s56, 109051904
    v_lshlrev_b32 v113, 7, v2
R_pollA:
    buffer_load_dword v112, v113, s[8:11], s56 offen sc1
    s_waitcnt vmcnt(0)
    v_cmp_gt_u32 vcc, s62, v112
    s_cbranch_vccnz R_pollA
    s_mov_b64 exec, s[64:65]
R_pa_done:
    s_barrier
    s_lshl_b32 s55, s61, 5
    s_add_u32 s55, s55, s50
    s_mul_i32 s55, s55, 49152
    s_add_u32 s55, s55, 96468992
    v_lshlrev_b32 v112, 4, v0
    v_cmp_gt_u32 vcc, 384, v0
    s_and_saveexec_b64 s[64:65], vcc
    s_add_u32 s56, s55, 0
    buffer_load_dwordx4 v[128:131], v112, s[8:11], s56 offen sc1
    s_add_u32 s56, s55, 6144
    buffer_load_dwordx4 v[132:135], v112, s[8:11], s56 offen sc1
    s_add_u32 s56, s55, 12288
    buffer_load_dwordx4 v[136:139], v112, s[8:11], s56 offen sc1
    s_add_u32 s56, s55, 18432
    buffer_load_dwordx4 v[140:143], v112, s[8:11], s56 offen sc1
    s_add_u32 s56, s55, 24576
    buffer_load_dwordx4 v[144:147], v112, s[8:11], s56 offen sc1
    s_add_u32 s56, s55, 30720
    buffer_load_dwordx4 v[148:151], v112, s[8:11], s56 offen sc1
    s_add_u32 s56, s55, 36864
    buffer_load_dwordx4 v[152:155], v112, s[8:11], s56 offen sc1
    s_add_u32 s56, s55, 43008
    buffer_load_dwordx4 v[156:159], v112, s[8:11], s56 offen sc1
    s_waitcnt vmcnt(0)
    v_mov_b32 v160, 0
    v_mov_b32 v161, 0
    v_mov_b32 v162, 0
    v_mov_b32 v163, 0
    v_mov_b32 v164, 0
    v_mov_b32 v165, 0
    v_mov_b32 v166, 0
    v_mov_b32 v167, 0
    v_lshlrev_b32 v168, 16, v128
    v_and_b32 v169, 0xffff0000, v128
    v_add_f32 v160, v160, v168
    v_add_f32 v161, v161, v169
    v_lshlrev_b32 v168, 16, v129
    v_and_b32 v169, 0xffff0000, v129
    v_add_f32 v162, v162, v168
    v_add_f32 v163, v163, v169
    v_lshlrev_b32 v168, 16, v130
    v_and_b32 v169, 0xffff0000, v130
    v_add_f32 v164, v164, v168
    v_add_f32 v165, v165, v169
    v_lshlrev_b32 v168, 16, v131
    v_and_b32 v169, 0xffff0000, v131
    v_add_f32 v166, v166, v168
    v_add_f32 v167, v167, v169
    v_lshlrev_b32 v168, 16, v132
    v_and_b32 v169, 0xffff0000, v132
    v_add_f32 v160, v160, v168
    v_add_f32 v161, v161, v169
    v_lshlrev_b32 v168, 16, v133
    v_and_b32 v169, 0xffff0000, v133
    v_add_f32 v162, v162, v168
    v_add_f32 v163, v163, v169
    v_lshlrev_b32 v168, 16, v134
    v_and_b32 v169, 0xffff0000, v134
    v_add_f32 v164, v164, v168
    v_add_f32 v165, v165, v169
    v_lshlrev_b32 v168, 16, v135
    v_and_b32 v169, 0xffff0000, v135
    v_add_f32 v166, v166, v168
    v_add_f32 v167, v167, v169
    v_lshlrev_b32 v168, 16, v136
    v_and_b32 v169, 0xffff0000, v136
    v_add_f32 v160, v160, v168
    v_add_f32 v161, v161, v169
    v_lshlrev_b32 v168, 16, v137
    v_and_b32 v169, 0xffff0000, v137
    v_add_f32 v162, v162, v168
    v_add_f32 v163, v163, v169
    v_lshlrev_b32 v168, 16, v138
    v_and_b32 v169, 0xffff0000, v138
    v_add_f32 v164, v164, v168
    v_add_f32 v165, v165, v169
    v_lshlrev_b32 v168, 16, v139
    v_and_b32 v169, 0xffff0000, v139
    v_add_f32 v166, v166, v168
    v_add_f32 v167, v167, v169
    v_lshlrev_b32 v168, 16, v140
    v_and_b32 v169, 0xffff0000, v140
    v_add_f32 v160, v160, v168
    v_add_f32 v161, v161, v169
    v_lshlrev_b32 v168, 16, v141
    v_and_b32 v169, 0xffff0000, v141
    v_add_f32 v162, v162, v168
    v_add_f32 v163, v163, v169
    v_lshlrev_b32 v168, 16, v142
    v_and_b32 v169, 0xffff0000, v142
    v_add_f32 v164, v164, v168
    v_add_f32 v165, v165, v169
    v_lshlrev_b32 v168, 16, v143
    v_and_b32 v169, 0xffff0000, v143
    v_add_f32 v166, v166, v168
    v_add_f32 v167, v167, v169
    v_lshlrev_b32 v168, 16, v144
    v_and_b32 v169, 0xffff0000, v144
    v_add_f32 v160, v160, v168
    v_add_f32 v161, v161, v169
    v_lshlrev_b32 v168, 16, v145
    v_and_b32 v169, 0xffff0000, v145
    v_add_f32 v162, v162, v168
    v_add_f32 v163, v163, v169
    v_lshlrev_b32 v168, 16, v146
    v_and_b32 v169, 0xffff0000, v146
    v_add_f32 v164, v164, v168
    v_add_f32 v165, v165, v169
    v_lshlrev_b32 v168, 16, v147
    v_and_b32 v169, 0xffff0000, v147
    v_add_f32 v166, v166, v168
    v_add_f32 v167, v167, v169
    v_lshlrev_b32 v168, 16, v148
    v_and_b32 v169, 0xffff0000, v148
    v_add_f32 v160, v160, v168
    v_add_f32 v161, v161, v169
    v_lshlrev_b32 v168, 16, v149
    v_and_b32 v169, 0xffff0000, v149
    v_add_f32 v162, v162, v168
    v_add_f32 v163, v163, v169
    v_lshlrev_b32 v168, 16, v150
    v_and_b32 v169, 0xffff0000, v150
    v_add_f32 v164, v164, v168
    v_add_f32 v165, v165, v169
    v_lshlrev_b32 v168, 16, v151
    v_and_b32 v169, 0xffff0000, v151
    v_add_f32 v166, v166, v168
    v_add_f32 v167, v167, v169
    v_lshlrev_b32 v168, 16, v152
    v_and_b32 v169, 0xffff0000, v152
    v_add_f32 v160, v160, v168
    v_add_f32 v161, v161, v169
    v_lshlrev_b32 v168, 16, v153
    v_and_b32 v169, 0xffff0000, v153
    v_add_f32 v162, v162, v168
    v_add_f32 v163, v163, v169
    v_lshlrev_b32 v168, 16, v154
    v_and_b32 v169, 0xffff0000, v154
    v_add_f32 v164, v164, v168
    v_add_f32 v165, v165, v169
    v_lshlrev_b32 v168, 16, v155
    v_and_b32 v169, 0xffff0000, v155
    v_add_f32 v166, v166, v168
    v_add_f32 v167, v167, v169
    v_lshlrev_b32 v168, 16, v156
    v_and_b32 v169, 0xffff0000, v156
    v_add_f32 v160, v160, v168
    v_add_f32 v161, v161, v169
    v_lshlrev_b32 v168, 16, v157
    v_and_b32 v169, 0xffff0000, v157
    v_add_f32 v162, v162, v168
    v_add_f32 v163, v163, v169
    v_lshlrev_b32 v168, 16, v158
    v_and_b32 v169, 0xffff0000, v158
    v_add_f32 v164, v164, v168
    v_add_f32 v165, v165, v169
    v_lshlrev_b32 v168, 16, v159
    v_and_b32 v169, 0xffff0000, v159
    v_add_f32 v166, v166, v168
    v_add_f32 v167, v167, v169
    v_cvt_pk_bf16_f32 v128, v160, v161
    v_cvt_pk_bf16_f32 v129, v162, v163
    v_cvt_pk_bf16_f32 v130, v164, v165
    v_cvt_pk_bf16_f32 v131, v166, v167
    s_mov_b32 s56, 43691
    v_mul_lo_u32 v112, v0, s56
    v_lshrrev_b32 v112, 21, v112
    v_mul_u32_u24 v113, 48, v112
    v_sub_u32 v113, v0, v113
    v_mul_u32_u24 v114, 784, v112
    v_lshlrev_b32 v115, 4, v113
    v_add_u32 v114, v114, v115
    ds_write_b128 v114, v[128:131] offset:0
    v_cmp_le_u32 vcc, 32, v113
    s_and_b64 exec, exec, vcc
    v_mul_u32_u24 v121, 288, v112
    v_subrev_u32 v122, 32, v113
    v_lshlrev_b32 v122, 4, v122
    v_add_u32 v121, v121, v122
    ds_write_b128 v121, v[128:131] offset:21248
    s_mov_b64 exec, s[64:65]
    s_cmp_lg_u32 s51, 0
    s_cbranch_scc1 R_nokm
    s_lshl_b32 s55, s60, 16
    s_lshl_b32 s56, s50, 8
    s_add_u32 s55, s55, s56
    s_add_u32 s55, s55, 88080384
    v_cmp_gt_u32 vcc, 384, v0
    s_and_saveexec_b64 s[64:65], vcc
    v_cmp_le_u32 vcc, 16, v113
    s_and_b64 exec, exec, vcc
    v_lshlrev_b32 v121, 13, v112
    v_subrev_u32 v122, 16, v113
    v_lshlrev_b32 v122, 4, v122
    v_cmp_le_u32 vcc, 32, v113
    v_mov_b32 v123, 0
    v_mov_b32 v125, 4194048
    v_cndmask_b32 v123, v123, v125, vcc
    v_add_u32 v121, v121, v122
    v_add_u32 v121, v121, v123
    buffer_store_dwordx4 v[128:131], v121, s[8:11], s55 offen
    s_mov_b64 exec, s[64:65]
R_nokm:
    s_waitcnt lgkmcnt(0)
    s_barrier
    ds_read_b128 v[96:99], v9 offset:0
    ds_read_b128 v[112:115], v9 offset:256
    ds_read_b128 v[100:103], v9 offset:64
    ds_read_b128 v[116:119], v9 offset:320
    ds_read_b128 v[104:107], v9 offset:128
    ds_read_b128 v[120:123], v9 offset:384
    ds_read_b128 v[108:111], v9 offset:192
    ds_read_b128 v[124:127], v9 offset:448
    ds_read_b128 v[144:147], v8 offset:39680
    ds_read_b128 v[148:151], v8 offset:39744
    ds_read_b128 v[152:155], v8 offset:39808
    ds_read_b128 v[156:159], v8 offset:39872
    ds_read_b128 v[160:163], v8 offset:44032
    ds_read_b128 v[164:167], v8 offset:44096
    ds_read_b128 v[168:171], v8 offset:44160
    ds_read_b128 v[172:175], v8 offset:44224
    v_mov_b32 v128, 0
    v_mov_b32 v129, 0
    v_mov_b32 v130, 0
    v_mov_b32 v131, 0
    v_mov_b32 v132, 0
    v_mov_b32 v133, 0
    v_mov_b32 v134, 0
    v_mov_b32 v135, 0
    v_mov_b32 v136, 0
    v_mov_b32 v137, 0
    v_mov_b32 v138, 0
    v_mov_b32 v139, 0
    s_waitcnt lgkmcnt(0)
    s_nop 1
    v_mfma_f32_16x16x32_bf16 v[128:131], v[112:115], v[96:99], v[128:131]
    v_mfma_f32_16x16x32_bf16 v[132:135], v[144:147], v[96:99], v[132:135]
    v_mfma_f32_16x16x32_bf16 v[136:139], v[160:163], v[96:99], v[136:139]
    v_mfma_f32_16x16x32_bf16 v[128:131], v[116:119], v[100:103], v[128:131]
    v_mfma_f32_16x16x32_bf16 v[132:135], v[148:151], v[100:103], v[132:135]
    v_mfma_f32_16x16x32_bf16 v[136:139], v[164:167], v[100:103], v[136:139]
    v_mfma_f32_16x16x32_bf16 v[128:131], v[120:123], v[104:107], v[128:131]
    v_mfma_f32_16x16x32_bf16 v[132:135], v[152:155], v[104:107], v[132:135]
    v_mfma_f32_16x16x32_bf16 v[136:139], v[168:171], v[104:107], v[136:139]
    v_mfma_f32_16x16x32_bf16 v[128:131], v[124:127], v[108:111], v[128:131]
    v_mfma_f32_16x16x32_bf16 v[132:135], v[156:159], v[108:111], v[132:135]
    v_mfma_f32_16x16x32_bf16 v[136:139], v[172:175], v[108:111], v[136:139]
    s_mov_b32 s55, 0x3db504f3
    s_mov_b32 s56, 0x3fb8aa3b
    s_nop 6
    v_cvt_pk_bf16_f32 v140, v128, v129
    v_lshlrev_b32 v128, 16, v140
    v_and_b32 v129, 0xffff0000, v140
    v_mul_f32 v128, s55, v128
    v_mul_f32 v129, s55, v129
    v_cvt_pk_bf16_f32 v140, v128, v129
    v_lshlrev_b32 v128, 16, v140
    v_and_b32 v129, 0xffff0000, v140
    v_cvt_pk_bf16_f32 v140, v130, v131
    v_lshlrev_b32 v130, 16, v140
    v_and_b32 v131, 0xffff0000, v140
    v_mul_f32 v130, s55, v130
    v_mul_f32 v131, s55, v131
    v_cvt_pk_bf16_f32 v140, v130, v131
    v_lshlrev_b32 v130, 16, v140
    v_and_b32 v131, 0xffff0000, v140
    v_cvt_pk_bf16_f32 v140, v132, v133
    v_lshlrev_b32 v132, 16, v140
    v_and_b32 v133, 0xffff0000, v140
    v_mul_f32 v132, s55, v132
    v_mul_f32 v133, s55, v133
    v_cvt_pk_bf16_f32 v140, v132, v133
    v_lshlrev_b32 v132, 16, v140
    v_and_b32 v133, 0xffff0000, v140
    v_cvt_pk_bf16_f32 v140, v134, v135
    v_lshlrev_b32 v134, 16, v140
    v_and_b32 v135, 0xffff0000, v140
    v_mul_f32 v134, s55, v134
    v_mul_f32 v135, s55, v135
    v_cvt_pk_bf16_f32 v140, v134, v135
    v_lshlrev_b32 v134, 16, v140
    v_and_b32 v135, 0xffff0000, v140
    v_cvt_pk_bf16_f32 v140, v136, v137
    v_lshlrev_b32 v136, 16, v140
    v_and_b32 v137, 0xffff0000, v140
    v_mul_f32 v136, s55, v136
    v_mul_f32 v137, s55, v137
    v_cvt_pk_bf16_f32 v140, v136, v137
    v_lshlrev_b32 v136, 16, v140
    v_and_b32 v137, 0xffff0000, v140
    v_cvt_pk_bf16_f32 v140, v138, v139
    v_lshlrev_b32 v138, 16, v140
    v_and_b32 v139, 0xffff0000, v140
    v_mul_f32 v138, s55, v138
    v_mul_f32 v139, s55, v139
    v_cvt_pk_bf16_f32 v140, v138, v139
    v_lshlrev_b32 v138, 16, v140
    v_and_b32 v139, 0xffff0000, v140
    v_mov_b32 v141, 0xce6e6b28
    v_cmp_le_u32 vcc, 2, v4
    v_cndmask_b32 v128, v128, v141, vcc
    v_cndmask_b32 v129, v129, v141, vcc
    v_cndmask_b32 v130, v130, v141, vcc
    v_cndmask_b32 v131, v131, v141, vcc
    v_max_f32 v140, v128, v129
    v_max_f32 v140, v140, v130
    v_max_f32 v140, v140, v131
    v_max_f32 v140, v140, v132
    v_max_f32 v140, v140, v133
    v_max_f32 v140, v140, v134
    v_max_f32 v140, v140, v135
    v_max_f32 v140, v140, v136
    v_max_f32 v140, v140, v137
    v_max_f32 v140, v140, v138
    v_max_f32 v140, v140, v139
    ds_bpermute_b32 v141, v14, v140
    s_waitcnt lgkmcnt(0)
    v_max_f32 v140, v140, v141
    ds_bpermute_b32 v141, v15, v140
    s_waitcnt lgkmcnt(0)
    v_max_f32 v140, v140, v141
    v_mov_b32 v142, 0
    v_sub_f32 v128, v128, v140
    v_mul_f32 v128, s56, v128
    v_exp_f32 v128, v128
    s_nop 0
    v_add_f32 v142, v142, v128
    v_sub_f32 v129, v129, v140
    v_mul_f32 v129, s56, v129
    v_exp_f32 v129, v129
    s_nop 0
    v_add_f32 v142, v142, v129
    v_sub_f32 v130, v130, v140
    v_mul_f32 v130, s56, v130
    v_exp_f32 v130, v130
    s_nop 0
    v_add_f32 v142, v142, v130
    v_sub_f32 v131, v131, v140
    v_mul_f32 v131, s56, v131
    v_exp_f32 v131, v131
    s_nop 0
    v_add_f32 v142, v142, v131
    v_sub_f32 v132, v132, v140
    v_mul_f32 v132, s56, v132
    v_exp_f32 v132, v132
    s_nop 0
    v_add_f32 v142, v142, v132
    v_sub_f32 v133, v133, v140
    v_mul_f32 v133, s56, v133
    v_exp_f32 v133, v133
    s_nop 0
    v_add_f32 v142, v142, v133
    v_sub_f32 v134, v134, v140
    v_mul_f32 v134, s56, v134
    v_exp_f32 v134, v134
    s_nop 0
    v_add_f32 v142, v142, v134
    v_sub_f32 v135, v135, v140
    v_mul_f32 v135, s56, v135
    v_exp_f32 v135, v135
    s_nop 0
    v_add_f32 v142, v142, v135
    v_sub_f32 v136, v136, v140
    v_mul_f32 v136, s56, v136
    v_exp_f32 v136, v136
    s_nop 0
    v_add_f32 v142, v142, v136
    v_sub_f32 v137, v137, v140
    v_mul_f32 v137, s56, v137
    v_exp_f32 v137, v137
    s_nop 0
    v_add_f32 v142, v142, v137
    v_sub_f32 v138, v138, v140
    v_mul_f32 v138, s56, v138
    v_exp_f32 v138, v138
    s_nop 0
    v_add_f32 v142, v142, v138
    v_sub_f32 v139, v139, v140
    v_mul_f32 v139, s56, v139
    v_exp_f32 v139, v139
    s_nop 0
    v_add_f32 v142, v142, v139
    ds_bpermute_b32 v141, v14, v142
    s_waitcnt lgkmcnt(0)
    v_add_f32 v142, v142, v141
    ds_bpermute_b32 v141, v15, v142
    s_waitcnt lgkmcnt(0)
    v_add_f32 v142, v142, v141
    v_rcp_f32 v142, v142
    s_nop 0
    v_mul_f32 v128, v128, v142
    v_mul_f32 v129, v129, v142
    v_mul_f32 v130, v130, v142
    v_mul_f32 v131, v131, v142
    v_mul_f32 v132, v132, v142
    v_mul_f32 v133, v133, v142
    v_mul_f32 v134, v134, v142
    v_mul_f32 v135, v135, v142
    v_mul_f32 v136, v136, v142
    v_mul_f32 v137, v137, v142
    v_mul_f32 v138, v138, v142
    v_mul_f32 v139, v139, v142
    v_cvt_pk_bf16_f32 v144, v128, v129
    v_cvt_pk_bf16_f32 v145, v130, v131
    v_cvt_pk_bf16_f32 v146, v132, v133
    v_cvt_pk_bf16_f32 v147, v134, v135
    v_cvt_pk_bf16_f32 v148, v136, v137
    v_cvt_pk_bf16_f32 v149, v138, v139
    v_mov_b32 v150, 0
    v_mov_b32 v151, 0
    ds_read_b64_tr_b16 v[152:153], v12 offset:21248
    ds_read_b64_tr_b16 v[154:155], v12 offset:25856
    ds_read_b64_tr_b16 v[156:157], v12 offset:30464
    ds_read_b64_tr_b16 v[158:159], v12 offset:35072
    v_mov_b32 v160, 0
    v_mov_b32 v161, 0
    v_mov_b32 v162, 0
    v_mov_b32 v163, 0
    s_waitcnt lgkmcnt(0)
    s_nop 1
    v_mfma_f32_16x16x32_bf16 v[160:163], v[152:155], v[144:147], v[160:163]
    v_mfma_f32_16x16x32_bf16 v[160:163], v[156:159], v[148:151], v[160:163]
    s_nop 7
    s_nop 1
    v_cvt_pk_bf16_f32 v164, v160, v161
    v_cvt_pk_bf16_f32 v165, v162, v163
    ds_write_b64 v13, v[164:165] offset:16896
    s_waitcnt lgkmcnt(0)
    s_barrier
    s_add_u32 s68, s68, 262144
    buffer_load_dwordx4 v[80:83], v88, s[8:11], s68 offen
    s_add_u32 s57, s68, 16777216
    buffer_load_dwordx4 v[84:87], v88, s[8:11], s57 offen
    ds_read_b128 v[96:99], v8 offset:16896
    ds_read_b128 v[100:103], v8 offset:16960
    ds_read_b128 v[104:107], v8 offset:17024
    ds_read_b128 v[108:111], v8 offset:17088
    v_mov_b32 v128, 0
    v_mov_b32 v129, 0
    v_mov_b32 v130, 0
    v_mov_b32 v131, 0
    s_waitcnt lgkmcnt(0)
    s_nop 1
    v_mfma_f32_16x16x32_bf16 v[128:131], v[64:67], v[96:99], v[128:131]
    v_mfma_f32_16x16x32_bf16 v[128:131], v[68:71], v[100:103], v[128:131]
    v_mfma_f32_16x16x32_bf16 v[128:131], v[72:75], v[104:107], v[128:131]
    v_mfma_f32_16x16x32_bf16 v[128:131], v[76:79], v[108:111], v[128:131]
    s_lshl_b32 s55, s61, 3
    s_add_u32 s55, s55, s51
    s_lshl_b32 s55, s55, 5
    s_add_u32 s55, s55, s50
    s_lshl_b32 s55, s55, 11
    s_add_u32 s55, s55, 102760448
    v_cmp_gt_u32 vcc, 8, v3
    s_nop 4
    v_cvt_pk_bf16_f32 v128, v128, v129
    v_cvt_pk_bf16_f32 v129, v130, v131
    s_and_saveexec_b64 s[64:65], vcc
    buffer_store_dwordx2 v[128:129], v11, s[8:11], s55 offen sc1
    s_mov_b64 exec, s[64:65]
    s_waitcnt vmcnt(0)
    s_barrier
    s_cmp_lg_u32 s52, 0
    s_cbranch_scc1 R_pb_done
    s_lshl_b32 s55, s51, 5
    s_add_u32 s56, s55, s50
    s_lshl_b32 s56, s56, 7
    s_add_u32 s56, s56, 109084672
    v_mov_b32 v112, s62
    v_mov_b32 v113, 0
    v_cmp_gt_u32 vcc, 1, v2
    s_and_saveexec_b64 s[64:65], vcc
    buffer_store_dword v112, v113, s[8:11], s56 offen sc1
    s_mov_b64 exec, s[64:65]
    v_cmp_gt_u32 vcc, 32, v2
    s_and_saveexec_b64 s[64:65], vcc
    s_lshl_b32 s56, s55, 7
    s_add_u32 s56, s56, 109084672
    v_lshlrev_b32 v113, 7, v2
R_pollB:
    buffer_load_dword v112, v113, s[8:11], s56 offen sc1
    s_waitcnt vmcnt(0)
    v_cmp_gt_u32 vcc, s62, v112
    s_cbranch_vccnz R_pollB
    s_mov_b64 exec, s[64:65]
R_pb_done:
    s_barrier
    s_lshl_b32 s55, s61, 3
    s_add_u32 s55, s55, s51
    s_lshl_b32 s55, s55, 16
    s_add_u32 s55, s55, 102760448
    v_and_b32 v112, 127, v0
    v_lshlrev_b32 v112, 4, v112
    v_lshrrev_b32 v113, 7, v0
    v_lshlrev_b32 v113, 14, v113
    v_add_u32 v112, v112, v113
    s_add_u32 s56, s55, 0
    buffer_load_dwordx4 v[128:131], v112, s[8:11], s56 offen sc1
    s_add_u32 s56, s55, 2048
    buffer_load_dwordx4 v[132:135], v112, s[8:11], s56 offen sc1
    s_add_u32 s56, s55, 4096
    buffer_load_dwordx4 v[136:139], v112, s[8:11], s56 offen sc1
    s_add_u32 s56, s55, 6144
    buffer_load_dwordx4 v[140:143], v112, s[8:11], s56 offen sc1
    s_add_u32 s56, s55, 8192
    buffer_load_dwordx4 v[144:147], v112, s[8:11], s56 offen sc1
    s_add_u32 s56, s55, 10240
    buffer_load_dwordx4 v[148:151], v112, s[8:11], s56 offen sc1
    s_add_u32 s56, s55, 12288
    buffer_load_dwordx4 v[152:155], v112, s[8:11], s56 offen sc1
    s_add_u32 s56, s55, 14336
    buffer_load_dwordx4 v[156:159], v112, s[8:11], s56 offen sc1
    s_waitcnt vmcnt(0)
    v_mov_b32 v160, 0
    v_mov_b32 v161, 0
    v_mov_b32 v162, 0
    v_mov_b32 v163, 0
    v_mov_b32 v164, 0
    v_mov_b32 v165, 0
    v_mov_b32 v166, 0
    v_mov_b32 v167, 0
    v_lshlrev_b32 v168, 16, v128
    v_and_b32 v169, 0xffff0000, v128
    v_add_f32 v160, v160, v168
    v_add_f32 v161, v161, v169
    v_lshlrev_b32 v168, 16, v129
    v_and_b32 v169, 0xffff0000, v129
    v_add_f32 v162, v162, v168
    v_add_f32 v163, v163, v169
    v_lshlrev_b32 v168, 16, v130
    v_and_b32 v169, 0xffff0000, v130
    v_add_f32 v164, v164, v168
    v_add_f32 v165, v165, v169
    v_lshlrev_b32 v168, 16, v131
    v_and_b32 v169, 0xffff0000, v131
    v_add_f32 v166, v166, v168
    v_add_f32 v167, v167, v169
    v_lshlrev_b32 v168, 16, v132
    v_and_b32 v169, 0xffff0000, v132
    v_add_f32 v160, v160, v168
    v_add_f32 v161, v161, v169
    v_lshlrev_b32 v168, 16, v133
    v_and_b32 v169, 0xffff0000, v133
    v_add_f32 v162, v162, v168
    v_add_f32 v163, v163, v169
    v_lshlrev_b32 v168, 16, v134
    v_and_b32 v169, 0xffff0000, v134
    v_add_f32 v164, v164, v168
    v_add_f32 v165, v165, v169
    v_lshlrev_b32 v168, 16, v135
    v_and_b32 v169, 0xffff0000, v135
    v_add_f32 v166, v166, v168
    v_add_f32 v167, v167, v169
    v_lshlrev_b32 v168, 16, v136
    v_and_b32 v169, 0xffff0000, v136
    v_add_f32 v160, v160, v168
    v_add_f32 v161, v161, v169
    v_lshlrev_b32 v168, 16, v137
    v_and_b32 v169, 0xffff0000, v137
    v_add_f32 v162, v162, v168
    v_add_f32 v163, v163, v169
    v_lshlrev_b32 v168, 16, v138
    v_and_b32 v169, 0xffff0000, v138
    v_add_f32 v164, v164, v168
    v_add_f32 v165, v165, v169
    v_lshlrev_b32 v168, 16, v139
    v_and_b32 v169, 0xffff0000, v139
    v_add_f32 v166, v166, v168
    v_add_f32 v167, v167, v169
    v_lshlrev_b32 v168, 16, v140
    v_and_b32 v169, 0xffff0000, v140
    v_add_f32 v160, v160, v168
    v_add_f32 v161, v161, v169
    v_lshlrev_b32 v168, 16, v141
    v_and_b32 v169, 0xffff0000, v141
    v_add_f32 v162, v162, v168
    v_add_f32 v163, v163, v169
    v_lshlrev_b32 v168, 16, v142
    v_and_b32 v169, 0xffff0000, v142
    v_add_f32 v164, v164, v168
    v_add_f32 v165, v165, v169
    v_lshlrev_b32 v168, 16, v143
    v_and_b32 v169, 0xffff0000, v143
    v_add_f32 v166, v166, v168
    v_add_f32 v167, v167, v169
    v_lshlrev_b32 v168, 16, v144
    v_and_b32 v169, 0xffff0000, v144
    v_add_f32 v160, v160, v168
    v_add_f32 v161, v161, v169
    v_lshlrev_b32 v168, 16, v145
    v_and_b32 v169, 0xffff0000, v145
    v_add_f32 v162, v162, v168
    v_add_f32 v163, v163, v169
    v_lshlrev_b32 v168, 16, v146
    v_and_b32 v169, 0xffff0000, v146
    v_add_f32 v164, v164, v168
    v_add_f32 v165, v165, v169
    v_lshlrev_b32 v168, 16, v147
    v_and_b32 v169, 0xffff0000, v147
    v_add_f32 v166, v166, v168
    v_add_f32 v167, v167, v169
    v_lshlrev_b32 v168, 16, v148
    v_and_b32 v169, 0xffff0000, v148
    v_add_f32 v160, v160, v168
    v_add_f32 v161, v161, v169
    v_lshlrev_b32 v168, 16, v149
    v_and_b32 v169, 0xffff0000, v149
    v_add_f32 v162, v162, v168
    v_add_f32 v163, v163, v169
    v_lshlrev_b32 v168, 16, v150
    v_and_b32 v169, 0xffff0000, v150
    v_add_f32 v164, v164, v168
    v_add_f32 v165, v165, v169
    v_lshlrev_b32 v168, 16, v151
    v_and_b32 v169, 0xffff0000, v151
    v_add_f32 v166, v166, v168
    v_add_f32 v167, v167, v169
    v_lshlrev_b32 v168, 16, v152
    v_and_b32 v169, 0xffff0000, v152
    v_add_f32 v160, v160, v168
    v_add_f32 v161, v161, v169
    v_lshlrev_b32 v168, 16, v153
    v_and_b32 v169, 0xffff0000, v153
    v_add_f32 v162, v162, v168
    v_add_f32 v163, v163, v169
    v_lshlrev_b32 v168, 16, v154
    v_and_b32 v169, 0xffff0000, v154
    v_add_f32 v164, v164, v168
    v_add_f32 v165, v165, v169
    v_lshlrev_b32 v168, 16, v155
    v_and_b32 v169, 0xffff0000, v155
    v_add_f32 v166, v166, v168
    v_add_f32 v167, v167, v169
    v_lshlrev_b32 v168, 16, v156
    v_and_b32 v169, 0xffff0000, v156
    v_add_f32 v160, v160, v168
    v_add_f32 v161, v161, v169
    v_lshlrev_b32 v168, 16, v157
    v_and_b32 v169, 0xffff0000, v157
    v_add_f32 v162, v162, v168
    v_add_f32 v163, v163, v169
    v_lshlrev_b32 v168, 16, v158
    v_and_b32 v169, 0xffff0000, v158
    v_add_f32 v164, v164, v168
    v_add_f32 v165, v165, v169
    v_lshlrev_b32 v168, 16, v159
    v_and_b32 v169, 0xffff0000, v159
    v_add_f32 v166, v166, v168
    v_add_f32 v167, v167, v169
    v_lshlrev_b32 v112, 5, v0
    ds_write_b128 v112, v[160:163] offset:48384
    ds_write_b128 v112, v[164:167] offset:48400
    s_waitcnt lgkmcnt(0)
    s_barrier
    v_cmp_gt_u32 vcc, 128, v0
    s_and_saveexec_b64 s[64:65], vcc
    s_cbranch_execz R_gb_done
    ds_read_b128 v[132:135], v112 offset:52480
    ds_read_b128 v[136:139], v112 offset:52496
    s_waitcnt lgkmcnt(0)
    v_add_f32 v160, v160, v132
    v_add_f32 v164, v164, v136
    v_add_f32 v161, v161, v133
    v_add_f32 v165, v165, v137
    v_add_f32 v162, v162, v134
    v_add_f32 v166, v166, v138
    v_add_f32 v163, v163, v135
    v_add_f32 v167, v167, v139
    ds_read_b128 v[132:135], v112 offset:56576
    ds_read_b128 v[136:139], v112 offset:56592
    s_waitcnt lgkmcnt(0)
    v_add_f32 v160, v160, v132
    v_add_f32 v164, v164, v136
    v_add_f32 v161, v161, v133
    v_add_f32 v165, v165, v137
    v_add_f32 v162, v162, v134
    v_add_f32 v166, v166, v138
    v_add_f32 v163, v163, v135
    v_add_f32 v167, v167, v139
    ds_read_b128 v[132:135], v112 offset:60672
    ds_read_b128 v[136:139], v112 offset:60688
    s_waitcnt lgkmcnt(0)
    v_add_f32 v160, v160, v132
    v_add_f32 v164, v164, v136
    v_add_f32 v161, v161, v133
    v_add_f32 v165, v165, v137
    v_add_f32 v162, v162, v134
    v_add_f32 v166, v166, v138
    v_add_f32 v163, v163, v135
    v_add_f32 v167, v167, v139
    v_cvt_pk_bf16_f32 v128, v160, v161
    v_cvt_pk_bf16_f32 v129, v162, v163
    v_cvt_pk_bf16_f32 v130, v164, v165
    v_cvt_pk_bf16_f32 v131, v166, v167
    v_lshrrev_b32 v113, 4, v0
    v_and_b32 v114, 15, v0
    v_mul_u32_u24 v113, 272, v113
    v_lshlrev_b32 v114, 4, v114
    v_add_u32 v113, v113, v114
    ds_write_b128 v113, v[128:131] offset:12544
R_gb_done:
    s_mov_b64 exec, s[64:65]
    s_waitcnt lgkmcnt(0)
    s_barrier
    s_add_u32 s60, s60, 1
    s_cmp_lt_u32 s60, 64
    s_cbranch_scc1 R_step
R_done:
    s_endpgm
.globl att_kernel
.p2align 8
.type att_kernel,@function
att_kernel:
    s_cmp_ge_u32 s2, 512
    s_cbranch_scc1 A_done
    s_load_dwordx2 s[4:5], s[0:1], 112
    v_lshrrev_b32 v1, 6, v0
    v_and_b32 v2, 63, v0
    v_and_b32 v3, 15, v2
    v_lshrrev_b32 v4, 4, v2
    s_nop 0
    v_readfirstlane_b32 s52, v1
    s_lshl_b32 s50, s2, 2
    s_nop 2
    s_add_u32 s50, s50, s52
    s_and_b32 s51, s50, 31
    s_lshr_b32 s50, s50, 5
    s_mul_i32 s53, s52, 18432
    s_waitcnt lgkmcnt(0)
    s_mov_b32 s8, s4
    s_and_b32 s9, s5, 0xffff
    s_mov_b32 s10, 268435456
    s_mov_b32 s11, 0x00020000
    v_lshlrev_b32 v5, 13, v3
    v_lshlrev_b32 v6, 4, v4
    v_add_u32 v5, v5, v6
    s_lshl_b32 s54, s50, 18
    s_lshl_b32 s55, s51, 8
    s_add_u32 s54, s54, s55
    s_lshl_b32 s56, s50, 16
    s_add_u32 s56, s56, s55
    s_add_u32 s57, s54, 4194304
    buffer_load_dwordx4 v[32:35], v5, s[8:11], s57 offen
    s_add_u32 s57, s54, 4194368
    buffer_load_dwordx4 v[36:39], v5, s[8:11], s57 offen
    s_add_u32 s57, s54, 4194432
    buffer_load_dwordx4 v[40:43], v5, s[8:11], s57 offen
    s_add_u32 s57, s54, 4194496
    buffer_load_dwordx4 v[44:47], v5, s[8:11], s57 offen
    s_add_u32 s57, s54, 4325376
    buffer_load_dwordx4 v[48:51], v5, s[8:11], s57 offen
    s_add_u32 s57, s54, 4325440
    buffer_load_dwordx4 v[52:55], v5, s[8:11], s57 offen
    s_add_u32 s57, s54, 4325504
    buffer_load_dwordx4 v[56:59], v5, s[8:11], s57 offen
    s_add_u32 s57, s54, 4325568
    buffer_load_dwordx4 v[60:63], v5, s[8:11], s57 offen
    s_add_u32 s57, s54, 20971520
    buffer_load_dwordx4 v[64:67], v5, s[8:11], s57 offen
    s_add_u32 s57, s54, 20971584
    buffer_load_dwordx4 v[68:71], v5, s[8:11], s57 offen
    s_add_u32 s57, s54, 20971648
    buffer_load_dwordx4 v[72:75], v5, s[8:11], s57 offen
    s_add_u32 s57, s54, 20971712
    buffer_load_dwordx4 v[76:79], v5, s[8:11], s57 offen
    s_add_u32 s57, s54, 21102592
    buffer_load_dwordx4 v[80:83], v5, s[8:11], s57 offen
    s_add_u32 s57, s54, 21102656
    buffer_load_dwordx4 v[84:87], v5, s[8:11], s57 offen
    s_add_u32 s57, s54, 21102720
    buffer_load_dwordx4 v[88:91], v5, s[8:11], s57 offen
    s_add_u32 s57, s54, 21102784
    buffer_load_dwordx4 v[92:95], v5, s[8:11], s57 offen
    v_and_b32 v7, 7, v3
    v_lshlrev_b32 v7, 13, v7
    v_add_u32 v7, v7, v6
    s_add_u32 s57, s56, 88080384
    buffer_load_dwordx4 v[96:99], v7, s[8:11], s57 offen
    s_add_u32 s57, s56, 88080448
    buffer_load_dwordx4 v[100:103], v7, s[8:11], s57 offen
    s_add_u32 s57, s56, 88080512
    buffer_load_dwordx4 v[104:107], v7, s[8:11], s57 offen
    s_add_u32 s57, s56, 88080576
    buffer_load_dwordx4 v[108:111], v7, s[8:11], s57 offen
    v_lshrrev_b32 v8, 4, v2
    v_lshlrev_b32 v9, 4, v3
    v_lshlrev_b32 v10, 13, v8
    v_add_u32 v10, v10, v9
    v_mul_u32_u24 v11, 288, v8
    v_add_u32 v11, v11, v9
    v_add_u32 v11, s53, v11
    s_add_u32 s57, s54, 37748736
    buffer_load_dwordx4 v[112:115], v10, s[8:11], s57 offen
    s_add_u32 s57, s54, 37781504
    buffer_load_dwordx4 v[116:119], v10, s[8:11], s57 offen
    s_add_u32 s57, s54, 37814272
    buffer_load_dwordx4 v[120:123], v10, s[8:11], s57 offen
    s_add_u32 s57, s54, 37847040
    buffer_load_dwordx4 v[124:127], v10, s[8:11], s57 offen
    s_add_u32 s57, s54, 37879808
    buffer_load_dwordx4 v[128:131], v10, s[8:11], s57 offen
    s_add_u32 s57, s54, 37912576
    buffer_load_dwordx4 v[132:135], v10, s[8:11], s57 offen
    s_add_u32 s57, s54, 37945344
    buffer_load_dwordx4 v[136:139], v10, s[8:11], s57 offen
    s_add_u32 s57, s54, 37978112
    buffer_load_dwordx4 v[140:143], v10, s[8:11], s57 offen
    s_add_u32 s57, s56, 92274688
    buffer_load_dwordx4 v[144:147], v10, s[8:11], s57 offen
    s_add_u32 s57, s56, 92307456
    buffer_load_dwordx4 v[148:151], v10, s[8:11], s57 offen
    v_mov_b32 v152, 0
    v_mov_b32 v153, 0
    v_mov_b32 v154, 0
    v_mov_b32 v155, 0
    ds_write_b128 v11, v[152:155] offset:2304
    ds_write_b128 v11, v[152:155] offset:3456
    ds_write_b128 v11, v[152:155] offset:13824
    ds_write_b128 v11, v[152:155] offset:14976
    ds_write_b128 v11, v[152:155] offset:16128
    ds_write_b128 v11, v[152:155] offset:17280
    s_waitcnt vmcnt(0)
    ds_write_b128 v11, v[112:115] offset:4608
    ds_write_b128 v11, v[116:119] offset:5760
    ds_write_b128 v11, v[120:123] offset:6912
    ds_write_b128 v11, v[124:127] offset:8064
    ds_write_b128 v11, v[128:131] offset:9216
    ds_write_b128 v11, v[132:135] offset:10368
    ds_write_b128 v11, v[136:139] offset:11520
    ds_write_b128 v11, v[140:143] offset:12672
    ds_write_b128 v11, v[144:147] offset:0
    ds_write_b128 v11, v[148:151] offset:1152
    v_lshrrev_b32 v13, 2, v3
    v_lshlrev_b32 v12, 2, v4
    v_add_u32 v12, v12, v13
    v_mul_u32_u24 v12, 288, v12
    v_and_b32 v13, 3, v3
    v_lshlrev_b32 v13, 3, v13
    v_add_u32 v12, v12, v13
    v_add_u32 v12, s53, v12
    v_xor_b32 v14, 16, v2
    v_lshlrev_b32 v14, 2, v14
    v_xor_b32 v15, 32, v2
    v_lshlrev_b32 v15, 2, v15
    s_mov_b32 s55, 0x3db504f3
    s_mov_b32 s56, 0x3fb8aa3b
    v_lshlrev_b32 v16, 13, v3
    v_lshlrev_b32 v17, 3, v4
    v_add_u32 v16, v16, v17
    v_lshlrev_b32 v18, 2, v4
    s_waitcnt lgkmcnt(0)
    v_mov_b32 v128, 0
    v_mov_b32 v129, 0
    v_mov_b32 v130, 0
    v_mov_b32 v131, 0
    v_mov_b32 v132, 0
    v_mov_b32 v133, 0
    v_mov_b32 v134, 0
    v_mov_b32 v135, 0
    v_mov_b32 v136, 0
    v_mov_b32 v137, 0
    v_mov_b32 v138, 0
    v_mov_b32 v139, 0
    s_nop 1
    v_mfma_f32_16x16x32_bf16 v[128:131], v[96:99], v[32:35], v[128:131]
    v_mfma_f32_16x16x32_bf16 v[132:135], v[64:67], v[32:35], v[132:135]
    v_mfma_f32_16x16x32_bf16 v[136:139], v[80:83], v[32:35], v[136:139]
    v_mfma_f32_16x16x32_bf16 v[128:131], v[100:103], v[36:39], v[128:131]
    v_mfma_f32_16x16x32_bf16 v[132:135], v[68:71], v[36:39], v[132:135]
    v_mfma_f32_16x16x32_bf16 v[136:139], v[84:87], v[36:39], v[136:139]
    v_mfma_f32_16x16x32_bf16 v[128:131], v[104:107], v[40:43], v[128:131]
    v_mfma_f32_16x16x32_bf16 v[132:135], v[72:75], v[40:43], v[132:135]
    v_mfma_f32_16x16x32_bf16 v[136:139], v[88:91], v[40:43], v[136:139]
    v_mfma_f32_16x16x32_bf16 v[128:131], v[108:111], v[44:47], v[128:131]
    v_mfma_f32_16x16x32_bf16 v[132:135], v[76:79], v[44:47], v[132:135]
    v_mfma_f32_16x16x32_bf16 v[136:139], v[92:95], v[44:47], v[136:139]
    s_nop 7
    v_cvt_pk_bf16_f32 v140, v128, v129
    v_lshlrev_b32 v128, 16, v140
    v_and_b32 v129, 0xffff0000, v140
    v_mul_f32 v128, s55, v128
    v_mul_f32 v129, s55, v129
    v_cvt_pk_bf16_f32 v140, v128, v129
    v_lshlrev_b32 v128, 16, v140
    v_and_b32 v129, 0xffff0000, v140
    v_cvt_pk_bf16_f32 v140, v130, v131
    v_lshlrev_b32 v130, 16, v140
    v_and_b32 v131, 0xffff0000, v140
    v_mul_f32 v130, s55, v130
    v_mul_f32 v131, s55, v131
    v_cvt_pk_bf16_f32 v140, v130, v131
    v_lshlrev_b32 v130, 16, v140
    v_and_b32 v131, 0xffff0000, v140
    v_cvt_pk_bf16_f32 v140, v132, v133
    v_lshlrev_b32 v132, 16, v140
    v_and_b32 v133, 0xffff0000, v140
    v_mul_f32 v132, s55, v132
    v_mul_f32 v133, s55, v133
    v_cvt_pk_bf16_f32 v140, v132, v133
    v_lshlrev_b32 v132, 16, v140
    v_and_b32 v133, 0xffff0000, v140
    v_cvt_pk_bf16_f32 v140, v134, v135
    v_lshlrev_b32 v134, 16, v140
    v_and_b32 v135, 0xffff0000, v140
    v_mul_f32 v134, s55, v134
    v_mul_f32 v135, s55, v135
    v_cvt_pk_bf16_f32 v140, v134, v135
    v_lshlrev_b32 v134, 16, v140
    v_and_b32 v135, 0xffff0000, v140
    v_cvt_pk_bf16_f32 v140, v136, v137
    v_lshlrev_b32 v136, 16, v140
    v_and_b32 v137, 0xffff0000, v140
    v_mul_f32 v136, s55, v136
    v_mul_f32 v137, s55, v137
    v_cvt_pk_bf16_f32 v140, v136, v137
    v_lshlrev_b32 v136, 16, v140
    v_and_b32 v137, 0xffff0000, v140
    v_cvt_pk_bf16_f32 v140, v138, v139
    v_lshlrev_b32 v138, 16, v140
    v_and_b32 v139, 0xffff0000, v140
    v_mul_f32 v138, s55, v138
    v_mul_f32 v139, s55, v139
    v_cvt_pk_bf16_f32 v140, v138, v139
    v_lshlrev_b32 v138, 16, v140
    v_and_b32 v139, 0xffff0000, v140
    v_mov_b32 v141, 0xce6e6b28
    v_cmp_le_u32 vcc, 2, v4
    v_cndmask_b32 v128, v128, v141, vcc
    v_cndmask_b32 v129, v129, v141, vcc
    v_cndmask_b32 v130, v130, v141, vcc
    v_cndmask_b32 v131, v131, v141, vcc
    v_add_u32 v142, 0, v3
    v_add_u32 v143, 0, v18
    v_cmp_gt_u32 vcc, v143, v142
    v_cndmask_b32 v132, v132, v141, vcc
    v_add_u32 v143, 1, v18
    v_cmp_gt_u32 vcc, v143, v142
    v_cndmask_b32 v133, v133, v141, vcc
    v_add_u32 v143, 2, v18
    v_cmp_gt_u32 vcc, v143, v142
    v_cndmask_b32 v134, v134, v141, vcc
    v_add_u32 v143, 3, v18
    v_cmp_gt_u32 vcc, v143, v142
    v_cndmask_b32 v135, v135, v141, vcc
    v_add_u32 v143, 16, v18
    v_cmp_gt_u32 vcc, v143, v142
    v_cndmask_b32 v136, v136, v141, vcc
    v_add_u32 v143, 17, v18
    v_cmp_gt_u32 vcc, v143, v142
    v_cndmask_b32 v137, v137, v141, vcc
    v_add_u32 v143, 18, v18
    v_cmp_gt_u32 vcc, v143, v142
    v_cndmask_b32 v138, v138, v141, vcc
    v_add_u32 v143, 19, v18
    v_cmp_gt_u32 vcc, v143, v142
    v_cndmask_b32 v139, v139, v141, vcc
    v_max_f32 v140, v128, v129
    v_max_f32 v140, v140, v130
    v_max_f32 v140, v140, v131
    v_max_f32 v140, v140, v132
    v_max_f32 v140, v140, v133
    v_max_f32 v140, v140, v134
    v_max_f32 v140, v140, v135
    v_max_f32 v140, v140, v136
    v_max_f32 v140, v140, v137
    v_max_f32 v140, v140, v138
    v_max_f32 v140, v140, v139
    ds_bpermute_b32 v141, v14, v140
    s_waitcnt lgkmcnt(0)
    v_max_f32 v140, v140, v141
    ds_bpermute_b32 v141, v15, v140
    s_waitcnt lgkmcnt(0)
    v_max_f32 v140, v140, v141
    v_mov_b32 v142, 0
    v_sub_f32 v128, v128, v140
    v_mul_f32 v128, s56, v128
    v_exp_f32 v128, v128
    s_nop 0
    v_add_f32 v142, v142, v128
    v_sub_f32 v129, v129, v140
    v_mul_f32 v129, s56, v129
    v_exp_f32 v129, v129
    s_nop 0
    v_add_f32 v142, v142, v129
    v_sub_f32 v130, v130, v140
    v_mul_f32 v130, s56, v130
    v_exp_f32 v130, v130
    s_nop 0
    v_add_f32 v142, v142, v130
    v_sub_f32 v131, v131, v140
    v_mul_f32 v131, s56, v131
    v_exp_f32 v131, v131
    s_nop 0
    v_add_f32 v142, v142, v131
    v_sub_f32 v132, v132, v140
    v_mul_f32 v132, s56, v132
    v_exp_f32 v132, v132
    s_nop 0
    v_add_f32 v142, v142, v132
    v_sub_f32 v133, v133, v140
    v_mul_f32 v133, s56, v133
    v_exp_f32 v133, v133
    s_nop 0
    v_add_f32 v142, v142, v133
    v_sub_f32 v134, v134, v140
    v_mul_f32 v134, s56, v134
    v_exp_f32 v134, v134
    s_nop 0
    v_add_f32 v142, v142, v134
    v_sub_f32 v135, v135, v140
    v_mul_f32 v135, s56, v135
    v_exp_f32 v135, v135
    s_nop 0
    v_add_f32 v142, v142, v135
    v_sub_f32 v136, v136, v140
    v_mul_f32 v136, s56, v136
    v_exp_f32 v136, v136
    s_nop 0
    v_add_f32 v142, v142, v136
    v_sub_f32 v137, v137, v140
    v_mul_f32 v137, s56, v137
    v_exp_f32 v137, v137
    s_nop 0
    v_add_f32 v142, v142, v137
    v_sub_f32 v138, v138, v140
    v_mul_f32 v138, s56, v138
    v_exp_f32 v138, v138
    s_nop 0
    v_add_f32 v142, v142, v138
    v_sub_f32 v139, v139, v140
    v_mul_f32 v139, s56, v139
    v_exp_f32 v139, v139
    s_nop 0
    v_add_f32 v142, v142, v139
    ds_bpermute_b32 v141, v14, v142
    s_waitcnt lgkmcnt(0)
    v_add_f32 v142, v142, v141
    ds_bpermute_b32 v141, v15, v142
    s_waitcnt lgkmcnt(0)
    v_add_f32 v142, v142, v141
    v_rcp_f32 v142, v142
    s_nop 0
    v_mul_f32 v128, v128, v142
    v_mul_f32 v129, v129, v142
    v_mul_f32 v130, v130, v142
    v_mul_f32 v131, v131, v142
    v_mul_f32 v132, v132, v142
    v_mul_f32 v133, v133, v142
    v_mul_f32 v134, v134, v142
    v_mul_f32 v135, v135, v142
    v_mul_f32 v136, v136, v142
    v_mul_f32 v137, v137, v142
    v_mul_f32 v138, v138, v142
    v_mul_f32 v139, v139, v142
    v_cvt_pk_bf16_f32 v144, v128, v129
    v_cvt_pk_bf16_f32 v145, v130, v131
    v_cvt_pk_bf16_f32 v146, v132, v133
    v_cvt_pk_bf16_f32 v147, v134, v135
    v_cvt_pk_bf16_f32 v148, v136, v137
    v_cvt_pk_bf16_f32 v149, v138, v139
    v_mov_b32 v150, 0
    v_mov_b32 v151, 0
    ds_read_b64_tr_b16 v[152:153], v12 offset:0
    ds_read_b64_tr_b16 v[154:155], v12 offset:4608
    ds_read_b64_tr_b16 v[156:157], v12 offset:9216
    ds_read_b64_tr_b16 v[158:159], v12 offset:13824
    v_mov_b32 v160, 0
    v_mov_b32 v161, 0
    v_mov_b32 v162, 0
    v_mov_b32 v163, 0
    s_waitcnt lgkmcnt(0)
    s_nop 1
    v_mfma_f32_16x16x32_bf16 v[160:163], v[152:155], v[144:147], v[160:163]
    v_mfma_f32_16x16x32_bf16 v[160:163], v[156:159], v[148:151], v[160:163]
    s_nop 7
    s_nop 1
    v_cvt_pk_bf16_f32 v164, v160, v161
    v_cvt_pk_bf16_f32 v165, v162, v163
    s_add_u32 s57, s54, 71303168
    buffer_store_dwordx2 v[164:165], v16, s[8:11], s57 offen
    ds_read_b64_tr_b16 v[152:153], v12 offset:32
    ds_read_b64_tr_b16 v[154:155], v12 offset:4640
    ds_read_b64_tr_b16 v[156:157], v12 offset:9248
    ds_read_b64_tr_b16 v[158:159], v12 offset:13856
    v_mov_b32 v160, 0
    v_mov_b32 v161, 0
    v_mov_b32 v162, 0
    v_mov_b32 v163, 0
    s_waitcnt lgkmcnt(0)
    s_nop 1
    v_mfma_f32_16x16x32_bf16 v[160:163], v[152:155], v[144:147], v[160:163]
    v_mfma_f32_16x16x32_bf16 v[160:163], v[156:159], v[148:151], v[160:163]
    s_nop 7
    s_nop 1
    v_cvt_pk_bf16_f32 v164, v160, v161
    v_cvt_pk_bf16_f32 v165, v162, v163
    s_add_u32 s57, s54, 71303200
    buffer_store_dwordx2 v[164:165], v16, s[8:11], s57 offen
    ds_read_b64_tr_b16 v[152:153], v12 offset:64
    ds_read_b64_tr_b16 v[154:155], v12 offset:4672
    ds_read_b64_tr_b16 v[156:157], v12 offset:9280
    ds_read_b64_tr_b16 v[158:159], v12 offset:13888
    v_mov_b32 v160, 0
    v_mov_b32 v161, 0
    v_mov_b32 v162, 0
    v_mov_b32 v163, 0
    s_waitcnt lgkmcnt(0)
    s_nop 1
    v_mfma_f32_16x16x32_bf16 v[160:163], v[152:155], v[144:147], v[160:163]
    v_mfma_f32_16x16x32_bf16 v[160:163], v[156:159], v[148:151], v[160:163]
    s_nop 7
    s_nop 1
    v_cvt_pk_bf16_f32 v164, v160, v161
    v_cvt_pk_bf16_f32 v165, v162, v163
    s_add_u32 s57, s54, 71303232
    buffer_store_dwordx2 v[164:165], v16, s[8:11], s57 offen
    ds_read_b64_tr_b16 v[152:153], v12 offset:96
    ds_read_b64_tr_b16 v[154:155], v12 offset:4704
    ds_read_b64_tr_b16 v[156:157], v12 offset:9312
    ds_read_b64_tr_b16 v[158:159], v12 offset:13920
    v_mov_b32 v160, 0
    v_mov_b32 v161, 0
    v_mov_b32 v162, 0
    v_mov_b32 v163, 0
    s_waitcnt lgkmcnt(0)
    s_nop 1
    v_mfma_f32_16x16x32_bf16 v[160:163], v[152:155], v[144:147], v[160:163]
    v_mfma_f32_16x16x32_bf16 v[160:163], v[156:159], v[148:151], v[160:163]
    s_nop 7
    s_nop 1
    v_cvt_pk_bf16_f32 v164, v160, v161
    v_cvt_pk_bf16_f32 v165, v162, v163
    s_add_u32 s57, s54, 71303264
    buffer_store_dwordx2 v[164:165], v16, s[8:11], s57 offen
    ds_read_b64_tr_b16 v[152:153], v12 offset:128
    ds_read_b64_tr_b16 v[154:155], v12 offset:4736
    ds_read_b64_tr_b16 v[156:157], v12 offset:9344
    ds_read_b64_tr_b16 v[158:159], v12 offset:13952
    v_mov_b32 v160, 0
    v_mov_b32 v161, 0
    v_mov_b32 v162, 0
    v_mov_b32 v163, 0
    s_waitcnt lgkmcnt(0)
    s_nop 1
    v_mfma_f32_16x16x32_bf16 v[160:163], v[152:155], v[144:147], v[160:163]
    v_mfma_f32_16x16x32_bf16 v[160:163], v[156:159], v[148:151], v[160:163]
    s_nop 7
    s_nop 1
    v_cvt_pk_bf16_f32 v164, v160, v161
    v_cvt_pk_bf16_f32 v165, v162, v163
    s_add_u32 s57, s54, 71303296
    buffer_store_dwordx2 v[164:165], v16, s[8:11], s57 offen
    ds_read_b64_tr_b16 v[152:153], v12 offset:160
    ds_read_b64_tr_b16 v[154:155], v12 offset:4768
    ds_read_b64_tr_b16 v[156:157], v12 offset:9376
    ds_read_b64_tr_b16 v[158:159], v12 offset:13984
    v_mov_b32 v160, 0
    v_mov_b32 v161, 0
    v_mov_b32 v162, 0
    v_mov_b32 v163, 0
    s_waitcnt lgkmcnt(0)
    s_nop 1
    v_mfma_f32_16x16x32_bf16 v[160:163], v[152:155], v[144:147], v[160:163]
    v_mfma_f32_16x16x32_bf16 v[160:163], v[156:159], v[148:151], v[160:163]
    s_nop 7
    s_nop 1
    v_cvt_pk_bf16_f32 v164, v160, v161
    v_cvt_pk_bf16_f32 v165, v162, v163
    s_add_u32 s57, s54, 71303328
    buffer_store_dwordx2 v[164:165], v16, s[8:11], s57 offen
    ds_read_b64_tr_b16 v[152:153], v12 offset:192
    ds_read_b64_tr_b16 v[154:155], v12 offset:4800
    ds_read_b64_tr_b16 v[156:157], v12 offset:9408
    ds_read_b64_tr_b16 v[158:159], v12 offset:14016
    v_mov_b32 v160, 0
    v_mov_b32 v161, 0
    v_mov_b32 v162, 0
    v_mov_b32 v163, 0
    s_waitcnt lgkmcnt(0)
    s_nop 1
    v_mfma_f32_16x16x32_bf16 v[160:163], v[152:155], v[144:147], v[160:163]
    v_mfma_f32_16x16x32_bf16 v[160:163], v[156:159], v[148:151], v[160:163]
    s_nop 7
    s_nop 1
    v_cvt_pk_bf16_f32 v164, v160, v161
    v_cvt_pk_bf16_f32 v165, v162, v163
    s_add_u32 s57, s54, 71303360
    buffer_store_dwordx2 v[164:165], v16, s[8:11], s57 offen
    ds_read_b64_tr_b16 v[152:153], v12 offset:224
    ds_read_b64_tr_b16 v[154:155], v12 offset:4832
    ds_read_b64_tr_b16 v[156:157], v12 offset:9440
    ds_read_b64_tr_b16 v[158:159], v12 offset:14048
    v_mov_b32 v160, 0
    v_mov_b32 v161, 0
    v_mov_b32 v162, 0
    v_mov_b32 v163, 0
    s_waitcnt lgkmcnt(0)
    s_nop 1
    v_mfma_f32_16x16x32_bf16 v[160:163], v[152:155], v[144:147], v[160:163]
    v_mfma_f32_16x16x32_bf16 v[160:163], v[156:159], v[148:151], v[160:163]
    s_nop 7
    s_nop 1
    v_cvt_pk_bf16_f32 v164, v160, v161
    v_cvt_pk_bf16_f32 v165, v162, v163
    s_add_u32 s57, s54, 71303392
    buffer_store_dwordx2 v[164:165], v16, s[8:11], s57 offen
    v_mov_b32 v128, 0
    v_mov_b32 v129, 0
    v_mov_b32 v130, 0
    v_mov_b32 v131, 0
    v_mov_b32 v132, 0
    v_mov_b32 v133, 0
    v_mov_b32 v134, 0
    v_mov_b32 v135, 0
    v_mov_b32 v136, 0
    v_mov_b32 v137, 0
    v_mov_b32 v138, 0
    v_mov_b32 v139, 0
    s_nop 1
    v_mfma_f32_16x16x32_bf16 v[128:131], v[96:99], v[48:51], v[128:131]
    v_mfma_f32_16x16x32_bf16 v[132:135], v[64:67], v[48:51], v[132:135]
    v_mfma_f32_16x16x32_bf16 v[136:139], v[80:83], v[48:51], v[136:139]
    v_mfma_f32_16x16x32_bf16 v[128:131], v[100:103], v[52:55], v[128:131]
    v_mfma_f32_16x16x32_bf16 v[132:135], v[68:71], v[52:55], v[132:135]
    v_mfma_f32_16x16x32_bf16 v[136:139], v[84:87], v[52:55], v[136:139]
    v_mfma_f32_16x16x32_bf16 v[128:131], v[104:107], v[56:59], v[128:131]
    v_mfma_f32_16x16x32_bf16 v[132:135], v[72:75], v[56:59], v[132:135]
    v_mfma_f32_16x16x32_bf16 v[136:139], v[88:91], v[56:59], v[136:139]
    v_mfma_f32_16x16x32_bf16 v[128:131], v[108:111], v[60:63], v[128:131]
    v_mfma_f32_16x16x32_bf16 v[132:135], v[76:79], v[60:63], v[132:135]
    v_mfma_f32_16x16x32_bf16 v[136:139], v[92:95], v[60:63], v[136:139]
    s_nop 7
    v_cvt_pk_bf16_f32 v140, v128, v129
    v_lshlrev_b32 v128, 16, v140
    v_and_b32 v129, 0xffff0000, v140
    v_mul_f32 v128, s55, v128
    v_mul_f32 v129, s55, v129
    v_cvt_pk_bf16_f32 v140, v128, v129
    v_lshlrev_b32 v128, 16, v140
    v_and_b32 v129, 0xffff0000, v140
    v_cvt_pk_bf16_f32 v140, v130, v131
    v_lshlrev_b32 v130, 16, v140
    v_and_b32 v131, 0xffff0000, v140
    v_mul_f32 v130, s55, v130
    v_mul_f32 v131, s55, v131
    v_cvt_pk_bf16_f32 v140, v130, v131
    v_lshlrev_b32 v130, 16, v140
    v_and_b32 v131, 0xffff0000, v140
    v_cvt_pk_bf16_f32 v140, v132, v133
    v_lshlrev_b32 v132, 16, v140
    v_and_b32 v133, 0xffff0000, v140
    v_mul_f32 v132, s55, v132
    v_mul_f32 v133, s55, v133
    v_cvt_pk_bf16_f32 v140, v132, v133
    v_lshlrev_b32 v132, 16, v140
    v_and_b32 v133, 0xffff0000, v140
    v_cvt_pk_bf16_f32 v140, v134, v135
    v_lshlrev_b32 v134, 16, v140
    v_and_b32 v135, 0xffff0000, v140
    v_mul_f32 v134, s55, v134
    v_mul_f32 v135, s55, v135
    v_cvt_pk_bf16_f32 v140, v134, v135
    v_lshlrev_b32 v134, 16, v140
    v_and_b32 v135, 0xffff0000, v140
    v_cvt_pk_bf16_f32 v140, v136, v137
    v_lshlrev_b32 v136, 16, v140
    v_and_b32 v137, 0xffff0000, v140
    v_mul_f32 v136, s55, v136
    v_mul_f32 v137, s55, v137
    v_cvt_pk_bf16_f32 v140, v136, v137
    v_lshlrev_b32 v136, 16, v140
    v_and_b32 v137, 0xffff0000, v140
    v_cvt_pk_bf16_f32 v140, v138, v139
    v_lshlrev_b32 v138, 16, v140
    v_and_b32 v139, 0xffff0000, v140
    v_mul_f32 v138, s55, v138
    v_mul_f32 v139, s55, v139
    v_cvt_pk_bf16_f32 v140, v138, v139
    v_lshlrev_b32 v138, 16, v140
    v_and_b32 v139, 0xffff0000, v140
    v_mov_b32 v141, 0xce6e6b28
    v_cmp_le_u32 vcc, 2, v4
    v_cndmask_b32 v128, v128, v141, vcc
    v_cndmask_b32 v129, v129, v141, vcc
    v_cndmask_b32 v130, v130, v141, vcc
    v_cndmask_b32 v131, v131, v141, vcc
    v_add_u32 v142, 16, v3
    v_add_u32 v143, 0, v18
    v_cmp_gt_u32 vcc, v143, v142
    v_cndmask_b32 v132, v132, v141, vcc
    v_add_u32 v143, 1, v18
    v_cmp_gt_u32 vcc, v143, v142
    v_cndmask_b32 v133, v133, v141, vcc
    v_add_u32 v143, 2, v18
    v_cmp_gt_u32 vcc, v143, v142
    v_cndmask_b32 v134, v134, v141, vcc
    v_add_u32 v143, 3, v18
    v_cmp_gt_u32 vcc, v143, v142
    v_cndmask_b32 v135, v135, v141, vcc
    v_add_u32 v143, 16, v18
    v_cmp_gt_u32 vcc, v143, v142
    v_cndmask_b32 v136, v136, v141, vcc
    v_add_u32 v143, 17, v18
    v_cmp_gt_u32 vcc, v143, v142
    v_cndmask_b32 v137, v137, v141, vcc
    v_add_u32 v143, 18, v18
    v_cmp_gt_u32 vcc, v143, v142
    v_cndmask_b32 v138, v138, v141, vcc
    v_add_u32 v143, 19, v18
    v_cmp_gt_u32 vcc, v143, v142
    v_cndmask_b32 v139, v139, v141, vcc
    v_max_f32 v140, v128, v129
    v_max_f32 v140, v140, v130
    v_max_f32 v140, v140, v131
    v_max_f32 v140, v140, v132
    v_max_f32 v140, v140, v133
    v_max_f32 v140, v140, v134
    v_max_f32 v140, v140, v135
    v_max_f32 v140, v140, v136
    v_max_f32 v140, v140, v137
    v_max_f32 v140, v140, v138
    v_max_f32 v140, v140, v139
    ds_bpermute_b32 v141, v14, v140
    s_waitcnt lgkmcnt(0)
    v_max_f32 v140, v140, v141
    ds_bpermute_b32 v141, v15, v140
    s_waitcnt lgkmcnt(0)
    v_max_f32 v140, v140, v141
    v_mov_b32 v142, 0
    v_sub_f32 v128, v128, v140
    v_mul_f32 v128, s56, v128
    v_exp_f32 v128, v128
    s_nop 0
    v_add_f32 v142, v142, v128
    v_sub_f32 v129, v129, v140
    v_mul_f32 v129, s56, v129
    v_exp_f32 v129, v129
    s_nop 0
    v_add_f32 v142, v142, v129
    v_sub_f32 v130, v130, v140
    v_mul_f32 v130, s56, v130
    v_exp_f32 v130, v130
    s_nop 0
    v_add_f32 v142, v142, v130
    v_sub_f32 v131, v131, v140
    v_mul_f32 v131, s56, v131
    v_exp_f32 v131, v131
    s_nop 0
    v_add_f32 v142, v142, v131
    v_sub_f32 v132, v132, v140
    v_mul_f32 v132, s56, v132
    v_exp_f32 v132, v132
    s_nop 0
    v_add_f32 v142, v142, v132
    v_sub_f32 v133, v133, v140
    v_mul_f32 v133, s56, v133
    v_exp_f32 v133, v133
    s_nop 0
    v_add_f32 v142, v142, v133
    v_sub_f32 v134, v134, v140
    v_mul_f32 v134, s56, v134
    v_exp_f32 v134, v134
    s_nop 0
    v_add_f32 v142, v142, v134
    v_sub_f32 v135, v135, v140
    v_mul_f32 v135, s56, v135
    v_exp_f32 v135, v135
    s_nop 0
    v_add_f32 v142, v142, v135
    v_sub_f32 v136, v136, v140
    v_mul_f32 v136, s56, v136
    v_exp_f32 v136, v136
    s_nop 0
    v_add_f32 v142, v142, v136
    v_sub_f32 v137, v137, v140
    v_mul_f32 v137, s56, v137
    v_exp_f32 v137, v137
    s_nop 0
    v_add_f32 v142, v142, v137
    v_sub_f32 v138, v138, v140
    v_mul_f32 v138, s56, v138
    v_exp_f32 v138, v138
    s_nop 0
    v_add_f32 v142, v142, v138
    v_sub_f32 v139, v139, v140
    v_mul_f32 v139, s56, v139
    v_exp_f32 v139, v139
    s_nop 0
    v_add_f32 v142, v142, v139
    ds_bpermute_b32 v141, v14, v142
    s_waitcnt lgkmcnt(0)
    v_add_f32 v142, v142, v141
    ds_bpermute_b32 v141, v15, v142
    s_waitcnt lgkmcnt(0)
    v_add_f32 v142, v142, v141
    v_rcp_f32 v142, v142
    s_nop 0
    v_mul_f32 v128, v128, v142
    v_mul_f32 v129, v129, v142
    v_mul_f32 v130, v130, v142
    v_mul_f32 v131, v131, v142
    v_mul_f32 v132, v132, v142
    v_mul_f32 v133, v133, v142
    v_mul_f32 v134, v134, v142
    v_mul_f32 v135, v135, v142
    v_mul_f32 v136, v136, v142
    v_mul_f32 v137, v137, v142
    v_mul_f32 v138, v138, v142
    v_mul_f32 v139, v139, v142
    v_cvt_pk_bf16_f32 v144, v128, v129
    v_cvt_pk_bf16_f32 v145, v130, v131
    v_cvt_pk_bf16_f32 v146, v132, v133
    v_cvt_pk_bf16_f32 v147, v134, v135
    v_cvt_pk_bf16_f32 v148, v136, v137
    v_cvt_pk_bf16_f32 v149, v138, v139
    v_mov_b32 v150, 0
    v_mov_b32 v151, 0
    ds_read_b64_tr_b16 v[152:153], v12 offset:0
    ds_read_b64_tr_b16 v[154:155], v12 offset:4608
    ds_read_b64_tr_b16 v[156:157], v12 offset:9216
    ds_read_b64_tr_b16 v[158:159], v12 offset:13824
    v_mov_b32 v160, 0
    v_mov_b32 v161, 0
    v_mov_b32 v162, 0
    v_mov_b32 v163, 0
    s_waitcnt lgkmcnt(0)
    s_nop 1
    v_mfma_f32_16x16x32_bf16 v[160:163], v[152:155], v[144:147], v[160:163]
    v_mfma_f32_16x16x32_bf16 v[160:163], v[156:159], v[148:151], v[160:163]
    s_nop 7
    s_nop 1
    v_cvt_pk_bf16_f32 v164, v160, v161
    v_cvt_pk_bf16_f32 v165, v162, v163
    s_add_u32 s57, s54, 71434240
    buffer_store_dwordx2 v[164:165], v16, s[8:11], s57 offen
    ds_read_b64_tr_b16 v[152:153], v12 offset:32
    ds_read_b64_tr_b16 v[154:155], v12 offset:4640
    ds_read_b64_tr_b16 v[156:157], v12 offset:9248
    ds_read_b64_tr_b16 v[158:159], v12 offset:13856
    v_mov_b32 v160, 0
    v_mov_b32 v161, 0
    v_mov_b32 v162, 0
    v_mov_b32 v163, 0
    s_waitcnt lgkmcnt(0)
    s_nop 1
    v_mfma_f32_16x16x32_bf16 v[160:163], v[152:155], v[144:147], v[160:163]
    v_mfma_f32_16x16x32_bf16 v[160:163], v[156:159], v[148:151], v[160:163]
    s_nop 7
    s_nop 1
    v_cvt_pk_bf16_f32 v164, v160, v161
    v_cvt_pk_bf16_f32 v165, v162, v163
    s_add_u32 s57, s54, 71434272
    buffer_store_dwordx2 v[164:165], v16, s[8:11], s57 offen
    ds_read_b64_tr_b16 v[152:153], v12 offset:64
    ds_read_b64_tr_b16 v[154:155], v12 offset:4672
    ds_read_b64_tr_b16 v[156:157], v12 offset:9280
    ds_read_b64_tr_b16 v[158:159], v12 offset:13888
    v_mov_b32 v160, 0
    v_mov_b32 v161, 0
    v_mov_b32 v162, 0
    v_mov_b32 v163, 0
    s_waitcnt lgkmcnt(0)
    s_nop 1
    v_mfma_f32_16x16x32_bf16 v[160:163], v[152:155], v[144:147], v[160:163]
    v_mfma_f32_16x16x32_bf16 v[160:163], v[156:159], v[148:151], v[160:163]
    s_nop 7
    s_nop 1
    v_cvt_pk_bf16_f32 v164, v160, v161
    v_cvt_pk_bf16_f32 v165, v162, v163
    s_add_u32 s57, s54, 71434304
    buffer_store_dwordx2 v[164:165], v16, s[8:11], s57 offen
    ds_read_b64_tr_b16 v[152:153], v12 offset:96
    ds_read_b64_tr_b16 v[154:155], v12 offset:4704
    ds_read_b64_tr_b16 v[156:157], v12 offset:9312
    ds_read_b64_tr_b16 v[158:159], v12 offset:13920
    v_mov_b32 v160, 0
    v_mov_b32 v161, 0
    v_mov_b32 v162, 0
    v_mov_b32 v163, 0
    s_waitcnt lgkmcnt(0)
    s_nop 1
    v_mfma_f32_16x16x32_bf16 v[160:163], v[152:155], v[144:147], v[160:163]
    v_mfma_f32_16x16x32_bf16 v[160:163], v[156:159], v[148:151], v[160:163]
    s_nop 7
    s_nop 1
    v_cvt_pk_bf16_f32 v164, v160, v161
    v_cvt_pk_bf16_f32 v165, v162, v163
    s_add_u32 s57, s54, 71434336
    buffer_store_dwordx2 v[164:165], v16, s[8:11], s57 offen
    ds_read_b64_tr_b16 v[152:153], v12 offset:128
    ds_read_b64_tr_b16 v[154:155], v12 offset:4736
    ds_read_b64_tr_b16 v[156:157], v12 offset:9344
    ds_read_b64_tr_b16 v[158:159], v12 offset:13952
    v_mov_b32 v160, 0
    v_mov_b32 v161, 0
    v_mov_b32 v162, 0
    v_mov_b32 v163, 0
    s_waitcnt lgkmcnt(0)
    s_nop 1
    v_mfma_f32_16x16x32_bf16 v[160:163], v[152:155], v[144:147], v[160:163]
    v_mfma_f32_16x16x32_bf16 v[160:163], v[156:159], v[148:151], v[160:163]
    s_nop 7
    s_nop 1
    v_cvt_pk_bf16_f32 v164, v160, v161
    v_cvt_pk_bf16_f32 v165, v162, v163
    s_add_u32 s57, s54, 71434368
    buffer_store_dwordx2 v[164:165], v16, s[8:11], s57 offen
    ds_read_b64_tr_b16 v[152:153], v12 offset:160
    ds_read_b64_tr_b16 v[154:155], v12 offset:4768
    ds_read_b64_tr_b16 v[156:157], v12 offset:9376
    ds_read_b64_tr_b16 v[158:159], v12 offset:13984
    v_mov_b32 v160, 0
    v_mov_b32 v161, 0
    v_mov_b32 v162, 0
    v_mov_b32 v163, 0
    s_waitcnt lgkmcnt(0)
    s_nop 1
    v_mfma_f32_16x16x32_bf16 v[160:163], v[152:155], v[144:147], v[160:163]
    v_mfma_f32_16x16x32_bf16 v[160:163], v[156:159], v[148:151], v[160:163]
    s_nop 7
    s_nop 1
    v_cvt_pk_bf16_f32 v164, v160, v161
    v_cvt_pk_bf16_f32 v165, v162, v163
    s_add_u32 s57, s54, 71434400
    buffer_store_dwordx2 v[164:165], v16, s[8:11], s57 offen
    ds_read_b64_tr_b16 v[152:153], v12 offset:192
    ds_read_b64_tr_b16 v[154:155], v12 offset:4800
    ds_read_b64_tr_b16 v[156:157], v12 offset:9408
    ds_read_b64_tr_b16 v[158:159], v12 offset:14016
    v_mov_b32 v160, 0
    v_mov_b32 v161, 0
    v_mov_b32 v162, 0
    v_mov_b32 v163, 0
    s_waitcnt lgkmcnt(0)
    s_nop 1
    v_mfma_f32_16x16x32_bf16 v[160:163], v[152:155], v[144:147], v[160:163]
    v_mfma_f32_16x16x32_bf16 v[160:163], v[156:159], v[148:151], v[160:163]
    s_nop 7
    s_nop 1
    v_cvt_pk_bf16_f32 v164, v160, v161
    v_cvt_pk_bf16_f32 v165, v162, v163
    s_add_u32 s57, s54, 71434432
    buffer_store_dwordx2 v[164:165], v16, s[8:11], s57 offen
    ds_read_b64_tr_b16 v[152:153], v12 offset:224
    ds_read_b64_tr_b16 v[154:155], v12 offset:4832
    ds_read_b64_tr_b16 v[156:157], v12 offset:9440
    ds_read_b64_tr_b16 v[158:159], v12 offset:14048
    v_mov_b32 v160, 0
    v_mov_b32 v161, 0
    v_mov_b32 v162, 0
    v_mov_b32 v163, 0
    s_waitcnt lgkmcnt(0)
    s_nop 1
    v_mfma_f32_16x16x32_bf16 v[160:163], v[152:155], v[144:147], v[160:163]
    v_mfma_f32_16x16x32_bf16 v[160:163], v[156:159], v[148:151], v[160:163]
    s_nop 7
    s_nop 1
    v_cvt_pk_bf16_f32 v164, v160, v161
    v_cvt_pk_bf16_f32 v165, v162, v163
    s_add_u32 s57, s54, 71434464
    buffer_store_dwordx2 v[164:165], v16, s[8:11], s57 offen
A_done:
    s_endpgm
.globl gemm2_kernel
.p2align 8
.type gemm2_kernel,@function
gemm2_kernel:
    s_cmp_ge_u32 s2, 256
    s_cbranch_scc1 G2_done
    s_load_dwordx2 s[4:5], s[0:1], 112
    s_load_dwordx2 s[6:7], s[0:1], 40
    s_load_dwordx2 s[22:23], s[0:1], 80
    s_and_b32 s50, s2, 15
    s_lshr_b32 s51, s2, 4
    s_and_b32 s51, s51, 7
    s_cmp_ge_u32 s2, 128
    s_cbranch_scc1 G2_partB
    v_lshrrev_b32 v1, 3, v0
    v_and_b32 v2, 7, v0
    s_mov_b32 s30, 8192
    v_mul_lo_u32 v10, v1, s30
    v_lshlrev_b32 v3, 4, v2
    v_add_u32 v10, v10, v3
    v_mul_u32_u24 v12, 144, v1
    v_add_u32 v12, v12, v3
    v_add_u32 v13, 38912, v12
    v_lshrrev_b32 v1, 4, v0
    v_and_b32 v2, 15, v0
    s_mov_b32 s30, 2048
    v_mul_lo_u32 v11, v1, s30
    v_lshlrev_b32 v3, 4, v2
    v_add_u32 v11, v11, v3
    v_mul_u32_u24 v14, 320, v1
    v_add_u32 v14, v14, v3
    v_add_u32 v14, 18432, v14
    v_add_u32 v15, 38912, v14
    v_lshrrev_b32 v1, 6, v0
    v_and_b32 v2, 63, v0
    v_lshrrev_b32 v4, 1, v1
    v_and_b32 v5, 1, v1
    v_and_b32 v6, 31, v2
    v_lshrrev_b32 v7, 5, v2
    v_lshlrev_b32 v8, 6, v4
    v_add_u32 v8, v8, v6
    v_mul_u32_u24 v16, 144, v8
    v_lshlrev_b32 v9, 4, v7
    v_add_u32 v16, v16, v9
    v_add_u32 v17, 38912, v16
    v_lshrrev_b32 v6, 4, v2
    v_and_b32 v7, 15, v2
    v_lshrrev_b32 v8, 2, v7
    v_and_b32 v9, 3, v7
    v_lshrrev_b32 v20, 1, v6
    v_lshlrev_b32 v20, 3, v20
    v_add_u32 v20, v20, v8
    v_mul_u32_u24 v18, 320, v20
    v_and_b32 v21, 1, v6
    v_lshlrev_b32 v21, 4, v21
    v_lshlrev_b32 v22, 2, v9
    v_add_u32 v21, v21, v22
    v_lshlrev_b32 v22, 6, v5
    v_add_u32 v21, v21, v22
    v_lshlrev_b32 v21, 1, v21
    v_add_u32 v18, v18, v21
    v_add_u32 v18, 18432, v18
    v_add_u32 v19, 38912, v18
    s_waitcnt lgkmcnt(0)
    s_add_u32 s16, s4, 71303168
    s_addc_u32 s17, s5, 0
    s_mov_b32 s8, s16
    s_and_b32 s9, s17, 0xffff
    s_mov_b32 s10, 16777216
    s_mov_b32 s11, 0x00020000
    s_mov_b32 s12, s6
    s_and_b32 s13, s7, 0xffff
    s_mov_b32 s14, 8388608
    s_mov_b32 s15, 0x00020000
    s_lshl_b32 s55, s50, 20
    s_lshl_b32 s56, s51, 8
    s_add_u32 s40, s55, 0
    s_add_u32 s44, s56, 0
    s_add_u32 s41, s55, 262144
    s_add_u32 s45, s56, 32768
    s_add_u32 s42, s55, 524288
    s_add_u32 s46, s56, 65536
    s_add_u32 s43, s55, 786432
    s_add_u32 s47, s56, 98304
    v_mov_b32 v128, 0
    v_mov_b32 v129, 0
    v_mov_b32 v130, 0
    v_mov_b32 v131, 0
    v_mov_b32 v132, 0
    v_mov_b32 v133, 0
    v_mov_b32 v134, 0
    v_mov_b32 v135, 0
    v_mov_b32 v136, 0
    v_mov_b32 v137, 0
    v_mov_b32 v138, 0
    v_mov_b32 v139, 0
    v_mov_b32 v140, 0
    v_mov_b32 v141, 0
    v_mov_b32 v142, 0
    v_mov_b32 v143, 0
    v_mov_b32 v144, 0
    v_mov_b32 v145, 0
    v_mov_b32 v146, 0
    v_mov_b32 v147, 0
    v_mov_b32 v148, 0
    v_mov_b32 v149, 0
    v_mov_b32 v150, 0
    v_mov_b32 v151, 0
    v_mov_b32 v152, 0
    v_mov_b32 v153, 0
    v_mov_b32 v154, 0
    v_mov_b32 v155, 0
    v_mov_b32 v156, 0
    v_mov_b32 v157, 0
    v_mov_b32 v158, 0
    v_mov_b32 v159, 0
    v_mov_b32 v160, 0
    v_mov_b32 v161, 0
    v_mov_b32 v162, 0
    v_mov_b32 v163, 0
    v_mov_b32 v164, 0
    v_mov_b32 v165, 0
    v_mov_b32 v166, 0
    v_mov_b32 v167, 0
    v_mov_b32 v168, 0
    v_mov_b32 v169, 0
    v_mov_b32 v170, 0
    v_mov_b32 v171, 0
    v_mov_b32 v172, 0
    v_mov_b32 v173, 0
    v_mov_b32 v174, 0
    v_mov_b32 v175, 0
    v_mov_b32 v176, 0
    v_mov_b32 v177, 0
    v_mov_b32 v178, 0
    v_mov_b32 v179, 0
    v_mov_b32 v180, 0
    v_mov_b32 v181, 0
    v_mov_b32 v182, 0
    v_mov_b32 v183, 0
    v_mov_b32 v184, 0
    v_mov_b32 v185, 0
    v_mov_b32 v186, 0
    v_mov_b32 v187, 0
    v_mov_b32 v188, 0
    v_mov_b32 v189, 0
    v_mov_b32 v190, 0
    v_mov_b32 v191, 0
    buffer_load_dwordx4 v[32:35], v10, s[8:11], s40 offen
    buffer_load_dwordx4 v[36:39], v10, s[8:11], s41 offen
    buffer_load_dwordx4 v[40:43], v10, s[8:11], s42 offen
    buffer_load_dwordx4 v[44:47], v10, s[8:11], s43 offen
    buffer_load_dwordx4 v[48:51], v11, s[12:15], s44 offen
    buffer_load_dwordx4 v[52:55], v11, s[12:15], s45 offen
    buffer_load_dwordx4 v[56:59], v11, s[12:15], s46 offen
    buffer_load_dwordx4 v[60:63], v11, s[12:15], s47 offen
    s_add_u32 s40, s40, 128
    s_add_u32 s41, s41, 128
    s_add_u32 s42, s42, 128
    s_add_u32 s43, s43, 128
    s_add_u32 s44, s44, 131072
    s_add_u32 s45, s45, 131072
    s_add_u32 s46, s46, 131072
    s_add_u32 s47, s47, 131072
    s_waitcnt vmcnt(0)
    ds_write_b128 v12, v[32:35] offset:0
    ds_write_b128 v12, v[36:39] offset:4608
    ds_write_b128 v12, v[40:43] offset:9216
    ds_write_b128 v12, v[44:47] offset:13824
    ds_write_b128 v14, v[48:51] offset:0
    ds_write_b128 v14, v[52:55] offset:5120
    ds_write_b128 v14, v[56:59] offset:10240
    ds_write_b128 v14, v[60:63] offset:15360
    s_waitcnt lgkmcnt(0)
    s_barrier
    s_mov_b32 s48, 31
KL_16:
    buffer_load_dwordx4 v[32:35], v10, s[8:11], s40 offen
    buffer_load_dwordx4 v[36:39], v10, s[8:11], s41 offen
    buffer_load_dwordx4 v[40:43], v10, s[8:11], s42 offen
    buffer_load_dwordx4 v[44:47], v10, s[8:11], s43 offen
    buffer_load_dwordx4 v[48:51], v11, s[12:15], s44 offen
    buffer_load_dwordx4 v[52:55], v11, s[12:15], s45 offen
    buffer_load_dwordx4 v[56:59], v11, s[12:15], s46 offen
    buffer_load_dwordx4 v[60:63], v11, s[12:15], s47 offen
    s_add_u32 s40, s40, 128
    s_add_u32 s41, s41, 128
    s_add_u32 s42, s42, 128
    s_add_u32 s43, s43, 128
    s_add_u32 s44, s44, 131072
    s_add_u32 s45, s45, 131072
    s_add_u32 s46, s46, 131072
    s_add_u32 s47, s47, 131072
    ds_read_b128 v[64:67], v16 offset:0
    ds_read_b128 v[68:71], v16 offset:4608
    ds_read_b64_tr_b16 v[72:73], v18 offset:0
    ds_read_b64_tr_b16 v[74:75], v18 offset:1280
    ds_read_b64_tr_b16 v[76:77], v18 offset:64
    ds_read_b64_tr_b16 v[78:79], v18 offset:1344
    ds_read_b128 v[80:83], v16 offset:32
    ds_read_b128 v[84:87], v16 offset:4640
    ds_read_b64_tr_b16 v[88:89], v18 offset:5120
    ds_read_b64_tr_b16 v[90:91], v18 offset:6400
    ds_read_b64_tr_b16 v[92:93], v18 offset:5184
    ds_read_b64_tr_b16 v[94:95], v18 offset:6464
    s_waitcnt lgkmcnt(6)
    v_mfma_f32_32x32x16_bf16 v[128:143], v[72:75], v[64:67], v[128:143]
    v_mfma_f32_32x32x16_bf16 v[144:159], v[72:75], v[68:71], v[144:159]
    v_mfma_f32_32x32x16_bf16 v[160:175], v[76:79], v[64:67], v[160:175]
    v_mfma_f32_32x32x16_bf16 v[176:191], v[76:79], v[68:71], v[176:191]
    ds_read_b128 v[64:67], v16 offset:64
    ds_read_b128 v[68:71], v16 offset:4672
    ds_read_b64_tr_b16 v[72:73], v18 offset:10240
    ds_read_b64_tr_b16 v[74:75], v18 offset:11520
    ds_read_b64_tr_b16 v[76:77], v18 offset:10304
    ds_read_b64_tr_b16 v[78:79], v18 offset:11584
    s_waitcnt lgkmcnt(6)
    v_mfma_f32_32x32x16_bf16 v[128:143], v[88:91], v[80:83], v[128:143]
    v_mfma_f32_32x32x16_bf16 v[144:159], v[88:91], v[84:87], v[144:159]
    v_mfma_f32_32x32x16_bf16 v[160:175], v[92:95], v[80:83], v[160:175]
    v_mfma_f32_32x32x16_bf16 v[176:191], v[92:95], v[84:87], v[176:191]
    ds_read_b128 v[80:83], v16 offset:96
    ds_read_b128 v[84:87], v16 offset:4704
    ds_read_b64_tr_b16 v[88:89], v18 offset:15360
    ds_read_b64_tr_b16 v[90:91], v18 offset:16640
    ds_read_b64_tr_b16 v[92:93], v18 offset:15424
    ds_read_b64_tr_b16 v[94:95], v18 offset:16704
    s_waitcnt lgkmcnt(6)
    v_mfma_f32_32x32x16_bf16 v[128:143], v[72:75], v[64:67], v[128:143]
    v_mfma_f32_32x32x16_bf16 v[144:159], v[72:75], v[68:71], v[144:159]
    v_mfma_f32_32x32x16_bf16 v[160:175], v[76:79], v[64:67], v[160:175]
    v_mfma_f32_32x32x16_bf16 v[176:191], v[76:79], v[68:71], v[176:191]
    s_waitcnt lgkmcnt(0)
    v_mfma_f32_32x32x16_bf16 v[128:143], v[88:91], v[80:83], v[128:143]
    v_mfma_f32_32x32x16_bf16 v[144:159], v[88:91], v[84:87], v[144:159]
    v_mfma_f32_32x32x16_bf16 v[160:175], v[92:95], v[80:83], v[160:175]
    v_mfma_f32_32x32x16_bf16 v[176:191], v[92:95], v[84:87], v[176:191]
    s_waitcnt vmcnt(0)
    ds_write_b128 v13, v[32:35] offset:0
    ds_write_b128 v13, v[36:39] offset:4608
    ds_write_b128 v13, v[40:43] offset:9216
    ds_write_b128 v13, v[44:47] offset:13824
    ds_write_b128 v15, v[48:51] offset:0
    ds_write_b128 v15, v[52:55] offset:5120
    ds_write_b128 v15, v[56:59] offset:10240
    ds_write_b128 v15, v[60:63] offset:15360
    s_waitcnt lgkmcnt(0)
    s_barrier
    s_cmp_eq_u32 s48, 0
    s_cbranch_scc1 KS_17
    buffer_load_dwordx4 v[32:35], v10, s[8:11], s40 offen
    buffer_load_dwordx4 v[36:39], v10, s[8:11], s41 offen
    buffer_load_dwordx4 v[40:43], v10, s[8:11], s42 offen
    buffer_load_dwordx4 v[44:47], v10, s[8:11], s43 offen
    buffer_load_dwordx4 v[48:51], v11, s[12:15], s44 offen
    buffer_load_dwordx4 v[52:55], v11, s[12:15], s45 offen
    buffer_load_dwordx4 v[56:59], v11, s[12:15], s46 offen
    buffer_load_dwordx4 v[60:63], v11, s[12:15], s47 offen
    s_add_u32 s40, s40, 128
    s_add_u32 s41, s41, 128
    s_add_u32 s42, s42, 128
    s_add_u32 s43, s43, 128
    s_add_u32 s44, s44, 131072
    s_add_u32 s45, s45, 131072
    s_add_u32 s46, s46, 131072
    s_add_u32 s47, s47, 131072
KS_17:
    ds_read_b128 v[64:67], v17 offset:0
    ds_read_b128 v[68:71], v17 offset:4608
    ds_read_b64_tr_b16 v[72:73], v19 offset:0
    ds_read_b64_tr_b16 v[74:75], v19 offset:1280
    ds_read_b64_tr_b16 v[76:77], v19 offset:64
    ds_read_b64_tr_b16 v[78:79], v19 offset:1344
    ds_read_b128 v[80:83], v17 offset:32
    ds_read_b128 v[84:87], v17 offset:4640
    ds_read_b64_tr_b16 v[88:89], v19 offset:5120
    ds_read_b64_tr_b16 v[90:91], v19 offset:6400
    ds_read_b64_tr_b16 v[92:93], v19 offset:5184
    ds_read_b64_tr_b16 v[94:95], v19 offset:6464
    s_waitcnt lgkmcnt(6)
    v_mfma_f32_32x32x16_bf16 v[128:143], v[72:75], v[64:67], v[128:143]
    v_mfma_f32_32x32x16_bf16 v[144:159], v[72:75], v[68:71], v[144:159]
    v_mfma_f32_32x32x16_bf16 v[160:175], v[76:79], v[64:67], v[160:175]
    v_mfma_f32_32x32x16_bf16 v[176:191], v[76:79], v[68:71], v[176:191]
    ds_read_b128 v[64:67], v17 offset:64
    ds_read_b128 v[68:71], v17 offset:4672
    ds_read_b64_tr_b16 v[72:73], v19 offset:10240
    ds_read_b64_tr_b16 v[74:75], v19 offset:11520
    ds_read_b64_tr_b16 v[76:77], v19 offset:10304
    ds_read_b64_tr_b16 v[78:79], v19 offset:11584
    s_waitcnt lgkmcnt(6)
    v_mfma_f32_32x32x16_bf16 v[128:143], v[88:91], v[80:83], v[128:143]
    v_mfma_f32_32x32x16_bf16 v[144:159], v[88:91], v[84:87], v[144:159]
    v_mfma_f32_32x32x16_bf16 v[160:175], v[92:95], v[80:83], v[160:175]
    v_mfma_f32_32x32x16_bf16 v[176:191], v[92:95], v[84:87], v[176:191]
    ds_read_b128 v[80:83], v17 offset:96
    ds_read_b128 v[84:87], v17 offset:4704
    ds_read_b64_tr_b16 v[88:89], v19 offset:15360
    ds_read_b64_tr_b16 v[90:91], v19 offset:16640
    ds_read_b64_tr_b16 v[92:93], v19 offset:15424
    ds_read_b64_tr_b16 v[94:95], v19 offset:16704
    s_waitcnt lgkmcnt(6)
    v_mfma_f32_32x32x16_bf16 v[128:143], v[72:75], v[64:67], v[128:143]
    v_mfma_f32_32x32x16_bf16 v[144:159], v[72:75], v[68:71], v[144:159]
    v_mfma_f32_32x32x16_bf16 v[160:175], v[76:79], v[64:67], v[160:175]
    v_mfma_f32_32x32x16_bf16 v[176:191], v[76:79], v[68:71], v[176:191]
    s_waitcnt lgkmcnt(0)
    v_mfma_f32_32x32x16_bf16 v[128:143], v[88:91], v[80:83], v[128:143]
    v_mfma_f32_32x32x16_bf16 v[144:159], v[88:91], v[84:87], v[144:159]
    v_mfma_f32_32x32x16_bf16 v[160:175], v[92:95], v[80:83], v[160:175]
    v_mfma_f32_32x32x16_bf16 v[176:191], v[92:95], v[84:87], v[176:191]
    s_cmp_eq_u32 s48, 0
    s_cbranch_scc1 KE_18
    s_waitcnt vmcnt(0)
    ds_write_b128 v12, v[32:35] offset:0
    ds_write_b128 v12, v[36:39] offset:4608
    ds_write_b128 v12, v[40:43] offset:9216
    ds_write_b128 v12, v[44:47] offset:13824
    ds_write_b128 v14, v[48:51] offset:0
    ds_write_b128 v14, v[52:55] offset:5120
    ds_write_b128 v14, v[56:59] offset:10240
    ds_write_b128 v14, v[60:63] offset:15360
    s_waitcnt lgkmcnt(0)
    s_barrier
    s_sub_u32 s48, s48, 1
    s_branch KL_16
KE_18:
    s_barrier
    s_mov_b32 s57, 113246208
    s_branch G2_epi
G2_partB:
    v_lshrrev_b32 v1, 3, v0
    v_and_b32 v2, 7, v0
    s_mov_b32 s30, 7168
    v_mul_lo_u32 v10, v1, s30
    v_lshlrev_b32 v3, 4, v2
    v_add_u32 v10, v10, v3
    v_mul_u32_u24 v12, 144, v1
    v_add_u32 v12, v12, v3
    v_add_u32 v13, 38912, v12
    v_lshrrev_b32 v1, 4, v0
    v_and_b32 v2, 15, v0
    s_mov_b32 s30, 2048
    v_mul_lo_u32 v11, v1, s30
    v_lshlrev_b32 v3, 4, v2
    v_add_u32 v11, v11, v3
    v_mul_u32_u24 v14, 320, v1
    v_add_u32 v14, v14, v3
    v_add_u32 v14, 18432, v14
    v_add_u32 v15, 38912, v14
    v_lshrrev_b32 v1, 6, v0
    v_and_b32 v2, 63, v0
    v_lshrrev_b32 v4, 1, v1
    v_and_b32 v5, 1, v1
    v_and_b32 v6, 31, v2
    v_lshrrev_b32 v7, 5, v2
    v_lshlrev_b32 v8, 6, v4
    v_add_u32 v8, v8, v6
    v_mul_u32_u24 v16, 144, v8
    v_lshlrev_b32 v9, 4, v7
    v_add_u32 v16, v16, v9
    v_add_u32 v17, 38912, v16
    v_lshrrev_b32 v6, 4, v2
    v_and_b32 v7, 15, v2
    v_lshrrev_b32 v8, 2, v7
    v_and_b32 v9, 3, v7
    v_lshrrev_b32 v20, 1, v6
    v_lshlrev_b32 v20, 3, v20
    v_add_u32 v20, v20, v8
    v_mul_u32_u24 v18, 320, v20
    v_and_b32 v21, 1, v6
    v_lshlrev_b32 v21, 4, v21
    v_lshlrev_b32 v22, 2, v9
    v_add_u32 v21, v21, v22
    v_lshlrev_b32 v22, 6, v5
    v_add_u32 v21, v21, v22
    v_lshlrev_b32 v21, 1, v21
    v_add_u32 v18, v18, v21
    v_add_u32 v18, 18432, v18
    v_add_u32 v19, 38912, v18
    s_waitcnt lgkmcnt(0)
    s_add_u32 s16, s4, 54525952
    s_addc_u32 s17, s5, 0
    s_mov_b32 s8, s16
    s_and_b32 s9, s17, 0xffff
    s_mov_b32 s10, 14680064
    s_mov_b32 s11, 0x00020000
    s_mov_b32 s12, s22
    s_and_b32 s13, s23, 0xffff
    s_mov_b32 s14, 7340032
    s_mov_b32 s15, 0x00020000
    s_mul_i32 s55, s50, 917504
    s_lshl_b32 s56, s51, 8
    s_add_u32 s40, s55, 0
    s_add_u32 s44, s56, 0
    s_add_u32 s41, s55, 229376
    s_add_u32 s45, s56, 32768
    s_add_u32 s42, s55, 458752
    s_add_u32 s46, s56, 65536
    s_add_u32 s43, s55, 688128
    s_add_u32 s47, s56, 98304
    v_mov_b32 v128, 0
    v_mov_b32 v129, 0
    v_mov_b32 v130, 0
    v_mov_b32 v131, 0
    v_mov_b32 v132, 0
    v_mov_b32 v133, 0
    v_mov_b32 v134, 0
    v_mov_b32 v135, 0
    v_mov_b32 v136, 0
    v_mov_b32 v137, 0
    v_mov_b32 v138, 0
    v_mov_b32 v139, 0
    v_mov_b32 v140, 0
    v_mov_b32 v141, 0
    v_mov_b32 v142, 0
    v_mov_b32 v143, 0
    v_mov_b32 v144, 0
    v_mov_b32 v145, 0
    v_mov_b32 v146, 0
    v_mov_b32 v147, 0
    v_mov_b32 v148, 0
    v_mov_b32 v149, 0
    v_mov_b32 v150, 0
    v_mov_b32 v151, 0
    v_mov_b32 v152, 0
    v_mov_b32 v153, 0
    v_mov_b32 v154, 0
    v_mov_b32 v155, 0
    v_mov_b32 v156, 0
    v_mov_b32 v157, 0
    v_mov_b32 v158, 0
    v_mov_b32 v159, 0
    v_mov_b32 v160, 0
    v_mov_b32 v161, 0
    v_mov_b32 v162, 0
    v_mov_b32 v163, 0
    v_mov_b32 v164, 0
    v_mov_b32 v165, 0
    v_mov_b32 v166, 0
    v_mov_b32 v167, 0
    v_mov_b32 v168, 0
    v_mov_b32 v169, 0
    v_mov_b32 v170, 0
    v_mov_b32 v171, 0
    v_mov_b32 v172, 0
    v_mov_b32 v173, 0
    v_mov_b32 v174, 0
    v_mov_b32 v175, 0
    v_mov_b32 v176, 0
    v_mov_b32 v177, 0
    v_mov_b32 v178, 0
    v_mov_b32 v179, 0
    v_mov_b32 v180, 0
    v_mov_b32 v181, 0
    v_mov_b32 v182, 0
    v_mov_b32 v183, 0
    v_mov_b32 v184, 0
    v_mov_b32 v185, 0
    v_mov_b32 v186, 0
    v_mov_b32 v187, 0
    v_mov_b32 v188, 0
    v_mov_b32 v189, 0
    v_mov_b32 v190, 0
    v_mov_b32 v191, 0
    buffer_load_dwordx4 v[32:35], v10, s[8:11], s40 offen
    buffer_load_dwordx4 v[36:39], v10, s[8:11], s41 offen
    buffer_load_dwordx4 v[40:43], v10, s[8:11], s42 offen
    buffer_load_dwordx4 v[44:47], v10, s[8:11], s43 offen
    buffer_load_dwordx4 v[48:51], v11, s[12:15], s44 offen
    buffer_load_dwordx4 v[52:55], v11, s[12:15], s45 offen
    buffer_load_dwordx4 v[56:59], v11, s[12:15], s46 offen
    buffer_load_dwordx4 v[60:63], v11, s[12:15], s47 offen
    s_add_u32 s40, s40, 128
    s_add_u32 s41, s41, 128
    s_add_u32 s42, s42, 128
    s_add_u32 s43, s43, 128
    s_add_u32 s44, s44, 131072
    s_add_u32 s45, s45, 131072
    s_add_u32 s46, s46, 131072
    s_add_u32 s47, s47, 131072
    s_waitcnt vmcnt(0)
    ds_write_b128 v12, v[32:35] offset:0
    ds_write_b128 v12, v[36:39] offset:4608
    ds_write_b128 v12, v[40:43] offset:9216
    ds_write_b128 v12, v[44:47] offset:13824
    ds_write_b128 v14, v[48:51] offset:0
    ds_write_b128 v14, v[52:55] offset:5120
    ds_write_b128 v14, v[56:59] offset:10240
    ds_write_b128 v14, v[60:63] offset:15360
    s_waitcnt lgkmcnt(0)
    s_barrier
    s_mov_b32 s48, 27
KL_19:
    buffer_load_dwordx4 v[32:35], v10, s[8:11], s40 offen
    buffer_load_dwordx4 v[36:39], v10, s[8:11], s41 offen
    buffer_load_dwordx4 v[40:43], v10, s[8:11], s42 offen
    buffer_load_dwordx4 v[44:47], v10, s[8:11], s43 offen
    buffer_load_dwordx4 v[48:51], v11, s[12:15], s44 offen
    buffer_load_dwordx4 v[52:55], v11, s[12:15], s45 offen
    buffer_load_dwordx4 v[56:59], v11, s[12:15], s46 offen
    buffer_load_dwordx4 v[60:63], v11, s[12:15], s47 offen
    s_add_u32 s40, s40, 128
    s_add_u32 s41, s41, 128
    s_add_u32 s42, s42, 128
    s_add_u32 s43, s43, 128
    s_add_u32 s44, s44, 131072
    s_add_u32 s45, s45, 131072
    s_add_u32 s46, s46, 131072
    s_add_u32 s47, s47, 131072
    ds_read_b128 v[64:67], v16 offset:0
    ds_read_b128 v[68:71], v16 offset:4608
    ds_read_b64_tr_b16 v[72:73], v18 offset:0
    ds_read_b64_tr_b16 v[74:75], v18 offset:1280
    ds_read_b64_tr_b16 v[76:77], v18 offset:64
    ds_read_b64_tr_b16 v[78:79], v18 offset:1344
    ds_read_b128 v[80:83], v16 offset:32
    ds_read_b128 v[84:87], v16 offset:4640
    ds_read_b64_tr_b16 v[88:89], v18 offset:5120
    ds_read_b64_tr_b16 v[90:91], v18 offset:6400
    ds_read_b64_tr_b16 v[92:93], v18 offset:5184
    ds_read_b64_tr_b16 v[94:95], v18 offset:6464
    s_waitcnt lgkmcnt(6)
    v_mfma_f32_32x32x16_bf16 v[128:143], v[72:75], v[64:67], v[128:143]
    v_mfma_f32_32x32x16_bf16 v[144:159], v[72:75], v[68:71], v[144:159]
    v_mfma_f32_32x32x16_bf16 v[160:175], v[76:79], v[64:67], v[160:175]
    v_mfma_f32_32x32x16_bf16 v[176:191], v[76:79], v[68:71], v[176:191]
    ds_read_b128 v[64:67], v16 offset:64
    ds_read_b128 v[68:71], v16 offset:4672
    ds_read_b64_tr_b16 v[72:73], v18 offset:10240
    ds_read_b64_tr_b16 v[74:75], v18 offset:11520
    ds_read_b64_tr_b16 v[76:77], v18 offset:10304
    ds_read_b64_tr_b16 v[78:79], v18 offset:11584
    s_waitcnt lgkmcnt(6)
    v_mfma_f32_32x32x16_bf16 v[128:143], v[88:91], v[80:83], v[128:143]
    v_mfma_f32_32x32x16_bf16 v[144:159], v[88:91], v[84:87], v[144:159]
    v_mfma_f32_32x32x16_bf16 v[160:175], v[92:95], v[80:83], v[160:175]
    v_mfma_f32_32x32x16_bf16 v[176:191], v[92:95], v[84:87], v[176:191]
    ds_read_b128 v[80:83], v16 offset:96
    ds_read_b128 v[84:87], v16 offset:4704
    ds_read_b64_tr_b16 v[88:89], v18 offset:15360
    ds_read_b64_tr_b16 v[90:91], v18 offset:16640
    ds_read_b64_tr_b16 v[92:93], v18 offset:15424
    ds_read_b64_tr_b16 v[94:95], v18 offset:16704
    s_waitcnt lgkmcnt(6)
    v_mfma_f32_32x32x16_bf16 v[128:143], v[72:75], v[64:67], v[128:143]
    v_mfma_f32_32x32x16_bf16 v[144:159], v[72:75], v[68:71], v[144:159]
    v_mfma_f32_32x32x16_bf16 v[160:175], v[76:79], v[64:67], v[160:175]
    v_mfma_f32_32x32x16_bf16 v[176:191], v[76:79], v[68:71], v[176:191]
    s_waitcnt lgkmcnt(0)
    v_mfma_f32_32x32x16_bf16 v[128:143], v[88:91], v[80:83], v[128:143]
    v_mfma_f32_32x32x16_bf16 v[144:159], v[88:91], v[84:87], v[144:159]
    v_mfma_f32_32x32x16_bf16 v[160:175], v[92:95], v[80:83], v[160:175]
    v_mfma_f32_32x32x16_bf16 v[176:191], v[92:95], v[84:87], v[176:191]
    s_waitcnt vmcnt(0)
    ds_write_b128 v13, v[32:35] offset:0
    ds_write_b128 v13, v[36:39] offset:4608
    ds_write_b128 v13, v[40:43] offset:9216
    ds_write_b128 v13, v[44:47] offset:13824
    ds_write_b128 v15, v[48:51] offset:0
    ds_write_b128 v15, v[52:55] offset:5120
    ds_write_b128 v15, v[56:59] offset:10240
    ds_write_b128 v15, v[60:63] offset:15360
    s_waitcnt lgkmcnt(0)
    s_barrier
    s_cmp_eq_u32 s48, 0
    s_cbranch_scc1 KS_20
    buffer_load_dwordx4 v[32:35], v10, s[8:11], s40 offen
    buffer_load_dwordx4 v[36:39], v10, s[8:11], s41 offen
    buffer_load_dwordx4 v[40:43], v10, s[8:11], s42 offen
    buffer_load_dwordx4 v[44:47], v10, s[8:11], s43 offen
    buffer_load_dwordx4 v[48:51], v11, s[12:15], s44 offen
    buffer_load_dwordx4 v[52:55], v11, s[12:15], s45 offen
    buffer_load_dwordx4 v[56:59], v11, s[12:15], s46 offen
    buffer_load_dwordx4 v[60:63], v11, s[12:15], s47 offen
    s_add_u32 s40, s40, 128
    s_add_u32 s41, s41, 128
    s_add_u32 s42, s42, 128
    s_add_u32 s43, s43, 128
    s_add_u32 s44, s44, 131072
    s_add_u32 s45, s45, 131072
    s_add_u32 s46, s46, 131072
    s_add_u32 s47, s47, 131072
KS_20:
    ds_read_b128 v[64:67], v17 offset:0
    ds_read_b128 v[68:71], v17 offset:4608
    ds_read_b64_tr_b16 v[72:73], v19 offset:0
    ds_read_b64_tr_b16 v[74:75], v19 offset:1280
    ds_read_b64_tr_b16 v[76:77], v19 offset:64
    ds_read_b64_tr_b16 v[78:79], v19 offset:1344
    ds_read_b128 v[80:83], v17 offset:32
    ds_read_b128 v[84:87], v17 offset:4640
    ds_read_b64_tr_b16 v[88:89], v19 offset:5120
    ds_read_b64_tr_b16 v[90:91], v19 offset:6400
    ds_read_b64_tr_b16 v[92:93], v19 offset:5184
    ds_read_b64_tr_b16 v[94:95], v19 offset:6464
    s_waitcnt lgkmcnt(6)
    v_mfma_f32_32x32x16_bf16 v[128:143], v[72:75], v[64:67], v[128:143]
    v_mfma_f32_32x32x16_bf16 v[144:159], v[72:75], v[68:71], v[144:159]
    v_mfma_f32_32x32x16_bf16 v[160:175], v[76:79], v[64:67], v[160:175]
    v_mfma_f32_32x32x16_bf16 v[176:191], v[76:79], v[68:71], v[176:191]
    ds_read_b128 v[64:67], v17 offset:64
    ds_read_b128 v[68:71], v17 offset:4672
    ds_read_b64_tr_b16 v[72:73], v19 offset:10240
    ds_read_b64_tr_b16 v[74:75], v19 offset:11520
    ds_read_b64_tr_b16 v[76:77], v19 offset:10304
    ds_read_b64_tr_b16 v[78:79], v19 offset:11584
    s_waitcnt lgkmcnt(6)
    v_mfma_f32_32x32x16_bf16 v[128:143], v[88:91], v[80:83], v[128:143]
    v_mfma_f32_32x32x16_bf16 v[144:159], v[88:91], v[84:87], v[144:159]
    v_mfma_f32_32x32x16_bf16 v[160:175], v[92:95], v[80:83], v[160:175]
    v_mfma_f32_32x32x16_bf16 v[176:191], v[92:95], v[84:87], v[176:191]
    ds_read_b128 v[80:83], v17 offset:96
    ds_read_b128 v[84:87], v17 offset:4704
    ds_read_b64_tr_b16 v[88:89], v19 offset:15360
    ds_read_b64_tr_b16 v[90:91], v19 offset:16640
    ds_read_b64_tr_b16 v[92:93], v19 offset:15424
    ds_read_b64_tr_b16 v[94:95], v19 offset:16704
    s_waitcnt lgkmcnt(6)
    v_mfma_f32_32x32x16_bf16 v[128:143], v[72:75], v[64:67], v[128:143]
    v_mfma_f32_32x32x16_bf16 v[144:159], v[72:75], v[68:71], v[144:159]
    v_mfma_f32_32x32x16_bf16 v[160:175], v[76:79], v[64:67], v[160:175]
    v_mfma_f32_32x32x16_bf16 v[176:191], v[76:79], v[68:71], v[176:191]
    s_waitcnt lgkmcnt(0)
    v_mfma_f32_32x32x16_bf16 v[128:143], v[88:91], v[80:83], v[128:143]
    v_mfma_f32_32x32x16_bf16 v[144:159], v[88:91], v[84:87], v[144:159]
    v_mfma_f32_32x32x16_bf16 v[160:175], v[92:95], v[80:83], v[160:175]
    v_mfma_f32_32x32x16_bf16 v[176:191], v[92:95], v[84:87], v[176:191]
    s_cmp_eq_u32 s48, 0
    s_cbranch_scc1 KE_21
    s_waitcnt vmcnt(0)
    ds_write_b128 v12, v[32:35] offset:0
    ds_write_b128 v12, v[36:39] offset:4608
    ds_write_b128 v12, v[40:43] offset:9216
    ds_write_b128 v12, v[44:47] offset:13824
    ds_write_b128 v14, v[48:51] offset:0
    ds_write_b128 v14, v[52:55] offset:5120
    ds_write_b128 v14, v[56:59] offset:10240
    ds_write_b128 v14, v[60:63] offset:15360
    s_waitcnt lgkmcnt(0)
    s_barrier
    s_sub_u32 s48, s48, 1
    s_branch KL_19
KE_21:
    s_barrier
    s_mov_b32 s57, 121634816
G2_epi:
    v_lshrrev_b32 v1, 6, v0
    v_and_b32 v2, 63, v0
    v_lshrrev_b32 v4, 1, v1
    v_and_b32 v5, 1, v1
    v_and_b32 v6, 31, v2
    v_lshrrev_b32 v7, 5, v2
    v_lshlrev_b32 v20, 6, v4
    v_add_u32 v20, v20, v6
    v_lshlrev_b32 v21, 6, v5
    v_lshlrev_b32 v7, 2, v7
    v_add_u32 v21, v21, v7
    s_add_u32 s16, s4, s57
    s_addc_u32 s17, s5, 0
    s_mov_b32 s16, s16
    s_and_b32 s17, s17, 0xffff
    s_mov_b32 s18, 8388608
    s_mov_b32 s19, 0x00020000
    s_lshl_b32 s55, s50, 7
    v_add_u32 v20, s55, v20
    s_lshl_b32 s56, s51, 7
    v_add_u32 v21, s56, v21
    v_lshlrev_b32 v20, 12, v20
    v_lshlrev_b32 v21, 2, v21
    v_add_u32 v22, v20, v21
    s_nop 8
    v_add_u32 v23, 0, v22
    buffer_store_dwordx4 v[128:131], v23, s[16:19], 0 offen
    v_add_u32 v23, 32, v22
    buffer_store_dwordx4 v[132:135], v23, s[16:19], 0 offen
    v_add_u32 v23, 64, v22
    buffer_store_dwordx4 v[136:139], v23, s[16:19], 0 offen
    v_add_u32 v23, 96, v22
    buffer_store_dwordx4 v[140:143], v23, s[16:19], 0 offen
    v_add_u32 v23, 131072, v22
    buffer_store_dwordx4 v[144:147], v23, s[16:19], 0 offen
    v_add_u32 v23, 131104, v22
    buffer_store_dwordx4 v[148:151], v23, s[16:19], 0 offen
    v_add_u32 v23, 131136, v22
    buffer_store_dwordx4 v[152:155], v23, s[16:19], 0 offen
    v_add_u32 v23, 131168, v22
    buffer_store_dwordx4 v[156:159], v23, s[16:19], 0 offen
    v_add_u32 v23, 128, v22
    buffer_store_dwordx4 v[160:163], v23, s[16:19], 0 offen
    v_add_u32 v23, 160, v22
    buffer_store_dwordx4 v[164:167], v23, s[16:19], 0 offen
    v_add_u32 v23, 192, v22
    buffer_store_dwordx4 v[168:171], v23, s[16:19], 0 offen
    v_add_u32 v23, 224, v22
    buffer_store_dwordx4 v[172:175], v23, s[16:19], 0 offen
    v_add_u32 v23, 131200, v22
    buffer_store_dwordx4 v[176:179], v23, s[16:19], 0 offen
    v_add_u32 v23, 131232, v22
    buffer_store_dwordx4 v[180:183], v23, s[16:19], 0 offen
    v_add_u32 v23, 131264, v22
    buffer_store_dwordx4 v[184:187], v23, s[16:19], 0 offen
    v_add_u32 v23, 131296, v22
    buffer_store_dwordx4 v[188:191], v23, s[16:19], 0 offen
G2_done:
    s_endpgm
.globl fin_kernel
.p2align 8
.type fin_kernel,@function
fin_kernel:
    s_cmp_ge_u32 s2, 1024
    s_cbranch_scc1 F_done
    s_load_dwordx2 s[4:5], s[0:1], 112
    s_load_dwordx2 s[6:7], s[0:1], 0
    s_load_dwordx2 s[22:23], s[0:1], 88
    s_load_dwordx2 s[26:27], s[0:1], 96
    s_lshl_b32 s3, s2, 8
    v_add_u32 v1, s3, v0
    v_lshlrev_b32 v2, 4, v1
    v_lshlrev_b32 v3, 5, v1
    v_and_b32 v4, 127, v1
    v_lshlrev_b32 v4, 4, v4
    s_waitcnt lgkmcnt(0)
    s_mov_b32 s8, s4
    s_and_b32 s9, s5, 0xffff
    s_mov_b32 s10, 268435456
    s_mov_b32 s11, 0x00020000
    s_mov_b32 s12, s6
    s_and_b32 s13, s7, 0xffff
    s_mov_b32 s14, 4194304
    s_mov_b32 s15, 0x00020000
    s_mov_b32 s16, s22
    s_and_b32 s17, s23, 0xffff
    s_mov_b32 s18, 2048
    s_mov_b32 s19, 0x00020000
    s_mov_b32 s28, s26
    s_and_b32 s29, s27, 0xffff
    s_mov_b32 s30, 4194304
    s_mov_b32 s31, 0x00020000
    s_mov_b32 s32, 113246208
    s_mov_b32 s33, 121634816
    buffer_load_dwordx4 v[8:11], v2, s[12:15], 0 offen
    buffer_load_dwordx4 v[12:15], v4, s[16:19], 0 offen
    buffer_load_dwordx4 v[16:19], v3, s[8:11], s32 offen
    buffer_load_dwordx4 v[20:23], v3, s[8:11], s32 offen offset:16
    buffer_load_dwordx4 v[24:27], v3, s[8:11], s33 offen
    buffer_load_dwordx4 v[28:31], v3, s[8:11], s33 offen offset:16
    s_waitcnt vmcnt(0)
    v_lshlrev_b32 v32, 16, v8
    v_and_b32 v33, 0xffff0000, v8
    v_lshlrev_b32 v34, 16, v12
    v_and_b32 v35, 0xffff0000, v12
    v_add_f32 v32, v32, v34
    v_add_f32 v33, v33, v35
    v_add_f32 v32, v32, v16
    v_add_f32 v33, v33, v17
    v_add_f32 v32, v32, v24
    v_add_f32 v33, v33, v25
    v_cvt_pk_bf16_f32 v36, v32, v33
    v_lshlrev_b32 v32, 16, v9
    v_and_b32 v33, 0xffff0000, v9
    v_lshlrev_b32 v34, 16, v13
    v_and_b32 v35, 0xffff0000, v13
    v_add_f32 v32, v32, v34
    v_add_f32 v33, v33, v35
    v_add_f32 v32, v32, v18
    v_add_f32 v33, v33, v19
    v_add_f32 v32, v32, v26
    v_add_f32 v33, v33, v27
    v_cvt_pk_bf16_f32 v37, v32, v33
    v_lshlrev_b32 v32, 16, v10
    v_and_b32 v33, 0xffff0000, v10
    v_lshlrev_b32 v34, 16, v14
    v_and_b32 v35, 0xffff0000, v14
    v_add_f32 v32, v32, v34
    v_add_f32 v33, v33, v35
    v_add_f32 v32, v32, v20
    v_add_f32 v33, v33, v21
    v_add_f32 v32, v32, v28
    v_add_f32 v33, v33, v29
    v_cvt_pk_bf16_f32 v38, v32, v33
    v_lshlrev_b32 v32, 16, v11
    v_and_b32 v33, 0xffff0000, v11
    v_lshlrev_b32 v34, 16, v15
    v_and_b32 v35, 0xffff0000, v15
    v_add_f32 v32, v32, v34
    v_add_f32 v33, v33, v35
    v_add_f32 v32, v32, v22
    v_add_f32 v33, v33, v23
    v_add_f32 v32, v32, v30
    v_add_f32 v33, v33, v31
    v_cvt_pk_bf16_f32 v39, v32, v33
    buffer_store_dwordx4 v[36:39], v2, s[28:31], 0 offen
F_done:
    s_endpgm
.section .rodata,"a"
.p2align 6
.amdhsa_kernel ln_kernel
  .amdhsa_next_free_vgpr 48
  .amdhsa_next_free_sgpr 102
  .amdhsa_accum_offset 48
  .amdhsa_group_segment_fixed_size 0
  .amdhsa_kernarg_size 120
  .amdhsa_user_sgpr_count 2
  .amdhsa_user_sgpr_kernarg_segment_ptr 1
  .amdhsa_system_sgpr_workgroup_id_x 1
.end_amdhsa_kernel
.p2align 6
.amdhsa_kernel gemm1_kernel
  .amdhsa_next_free_vgpr 192
  .amdhsa_next_free_sgpr 102
  .amdhsa_accum_offset 192
  .amdhsa_group_segment_fixed_size 0
  .amdhsa_kernarg_size 120
  .amdhsa_user_sgpr_count 2
  .amdhsa_user_sgpr_kernarg_segment_ptr 1
  .amdhsa_system_sgpr_workgroup_id_x 1
.end_amdhsa_kernel
.p2align 6
.amdhsa_kernel rec_kernel
  .amdhsa_next_free_vgpr 192
  .amdhsa_next_free_sgpr 102
  .amdhsa_accum_offset 192
  .amdhsa_group_segment_fixed_size 0
  .amdhsa_kernarg_size 120
  .amdhsa_user_sgpr_count 2
  .amdhsa_user_sgpr_kernarg_segment_ptr 1
  .amdhsa_system_sgpr_workgroup_id_x 1
.end_amdhsa_kernel
.p2align 6
.amdhsa_kernel att_kernel
  .amdhsa_next_free_vgpr 168
  .amdhsa_next_free_sgpr 102
  .amdhsa_accum_offset 168
  .amdhsa_group_segment_fixed_size 0
  .amdhsa_kernarg_size 120
  .amdhsa_user_sgpr_count 2
  .amdhsa_user_sgpr_kernarg_segment_ptr 1
  .amdhsa_system_sgpr_workgroup_id_x 1
.end_amdhsa_kernel
.p2align 6
.amdhsa_kernel gemm2_kernel
  .amdhsa_next_free_vgpr 192
  .amdhsa_next_free_sgpr 102
  .amdhsa_accum_offset 192
  .amdhsa_group_segment_fixed_size 0
  .amdhsa_kernarg_size 120
  .amdhsa_user_sgpr_count 2
  .amdhsa_user_sgpr_kernarg_segment_ptr 1
  .amdhsa_system_sgpr_workgroup_id_x 1
.end_amdhsa_kernel
.p2align 6
.amdhsa_kernel fin_kernel
  .amdhsa_next_free_vgpr 40
  .amdhsa_next_free_sgpr 102
  .amdhsa_accum_offset 40
  .amdhsa_group_segment_fixed_size 0
  .amdhsa_kernarg_size 120
  .amdhsa_user_sgpr_count 2
  .amdhsa_user_sgpr_kernarg_segment_ptr 1
  .amdhsa_system_sgpr_workgroup_id_x 1
.end_amdhsa_kernel
.p2align 6
```
